```python
import torch

def _softmax(x, axis=-1):
    return torch.softmax(x, dim=axis)
def _gelu(x):
    return torch.nn.functional.gelu(x, approximate="tanh")
def _silu(x):
    return torch.nn.functional.silu(x)
def _sigmoid(x):
    return torch.sigmoid(x)
def _layernorm(x, axis=-1, eps=1e-5):
    m = x.mean(dim=axis, keepdim=True)
    v = x.var(dim=axis, keepdim=True, unbiased=False)
    return (x - m) / torch.sqrt(v + eps)
def _scatter_add(tgt, idx, src, axis=0):
    return tgt.clone().index_add_(axis, idx, src)
def _segment_sum(src, seg, n):
    out = torch.zeros((n,) + src.shape[1:], dtype=src.dtype)
    return out.index_add_(0, seg, src)
def _pad(x, pw):
    flat = tuple(v for pair in reversed(pw) for v in pair)
    return torch.nn.functional.pad(x, flat)

kernel_name = 'gated_mix__ssm_conv_s4__linear_attn_block__prompt'

def setup_inputs():

    _w = (lambda a: (lambda t: t.to(torch.bfloat16) if t.is_floating_point() else t)(torch.as_tensor(a)))
    def _A_setup():
        B, L, D, N = 1, 2048, 512, 128
        A_re = -(lambda _x: torch.exp(torch.as_tensor(_x)))((lambda *s: torch.randn(*s, dtype=torch.bfloat16) * 6.4)(D, N))
        A_im = torch.pi * (lambda *s: torch.randn(*s, dtype=torch.bfloat16) * 0.05)(D, N)
        B_re = (lambda *s: torch.randn(*s, dtype=torch.bfloat16) * 0.2)(D, N)
        B_im = (lambda *s: torch.randn(*s, dtype=torch.bfloat16) * 0.2)(D, N)
        C_re = (lambda *s: torch.randn(*s, dtype=torch.bfloat16) * 0.2)(D, N)
        C_im = (lambda *s: torch.randn(*s, dtype=torch.bfloat16) * 0.2)(D, N)
        log_dt = (lambda *s: torch.randn(*s, dtype=torch.bfloat16) * 0.05)(D) * 0.5 - 4.0
        Dskip = (lambda *s: torch.randn(*s, dtype=torch.bfloat16) * 0.05)(D)
        return {
            "u": _w((lambda *s: torch.randn(*s, dtype=torch.bfloat16) * 0.05)(B, L, D)),
            "A_re": _w(A_re),
            "A_im": _w(A_im),
            "B_re": _w(B_re),
            "B_im": _w(B_im),
            "C_re": _w(C_re),
            "C_im": _w(C_im),
            "log_dt": _w(log_dt),
            "Dskip": _w(Dskip),
        }
    _A_in = _A_setup()

    def _B_setup():
        B, S, D = 1, 2048, 512
        return {
            "x": _w((lambda *s: torch.randn(*s, dtype=torch.bfloat16) * 0.05)(B, S, D)),
            "wqkv": _w((lambda *s: torch.randn(*s, dtype=torch.bfloat16) * 0.8)(D, 3 * D)),
            "wo": _w((lambda *s: torch.randn(*s, dtype=torch.bfloat16) * 0.05)(D, D)),
        }
    _B_in = _B_setup()

    return {
        "A_u": _A_in["u"],
        "A_A_re": _A_in["A_re"],
        "A_A_im": _A_in["A_im"],
        "A_B_re": _A_in["B_re"],
        "A_B_im": _A_in["B_im"],
        "A_C_re": _A_in["C_re"],
        "A_C_im": _A_in["C_im"],
        "A_log_dt": _A_in["log_dt"],
        "A_Dskip": _A_in["Dskip"],
        "B_x": _B_in["x"],
        "B_wqkv": _B_in["wqkv"],
        "B_wo": _B_in["wo"],
        "gate_w": _w((lambda *s: torch.randn(*s, dtype=torch.bfloat16) * 0.05)(512) * 16.0),
    }

def reference(A_u, A_A_re, A_A_im, A_B_re, A_B_im, A_C_re, A_C_im, A_log_dt, A_Dskip, B_x, B_wqkv, B_wo, gate_w):
    def _A_ref(u, A_re, A_im, B_re, B_im, C_re, C_im, log_dt, Dskip):
        Bsz, L, D = u.shape
        dt = torch.exp(log_dt)[:, None]
        A = A_re + 1j * A_im
        Bc = B_re + 1j * B_im
        Cc = C_re + 1j * C_im
        logdA = dt * A
        dB = dt * Bc
        l = (lambda x, dt: x.to(dt))(torch.arange(L), A_re.dtype)
        P = torch.exp(logdA[:, :, None] * l[None, None, :])
        K = torch.einsum("dn,dnl,dn->dl", Cc, P, dB).real
        L2 = 2 * L
        Kp = _pad(K, ((0, 0), (0, L)))
        up = (lambda x, *d: x.permute(*d))(u, 0, 2, 1)
        up = _pad(up, ((0, 0), (0, 0), (0, L)))
        Kf = (lambda x, axes=(-2,-1): torch.fft.rfft2(x.float(), dim=axes))(Kp[:, None, :], axes=(-2, -1))
        Uf = (lambda x, axes=(-2,-1): torch.fft.rfft2(x.float(), dim=axes))(up[:, :, None, :], axes=(-2, -1))
        Yf = Uf * Kf[None, :, :, :]
        y = (lambda x, s, axes=(-2,-1): torch.fft.irfft2(x, s=s, dim=axes).to(torch.bfloat16))(Yf, (1, L2), axes=(-2, -1))[:, :, 0, :L]
        y = (lambda x, *d: x.permute(*d))(y, 0, 2, 1) + u * Dskip[None, None, :]
        return y

    def _B_ref(x, wqkv, wo):
        B, S, D = x.shape
        H = 32; Dh = D // H
        qkv = (lambda x, *d: x.permute(*d))((x @ wqkv).reshape(B, S, 3, H, Dh), 2, 0, 3, 1, 4)
        q, k, v = qkv[0], qkv[1], qkv[2]
        phi = lambda t: torch.where(t > 0, t + 1, torch.exp(t)) + 1e-6
        pq, pk = phi(q), phi(k)
        kv = torch.einsum("bhsd,bhse->bhde", pk, v)
        z = torch.einsum("bhsd->bhd", pk)
        num = torch.einsum("bhqd,bhde->bhqe", pq, kv)
        den = torch.einsum("bhqd,bhd->bhq", pq, z)[..., None] + 1e-6
        o = num / den
        return (lambda x, *d: x.permute(*d))(o, 0, 2, 1, 3).reshape(B, S, D) @ wo

    x = A_u
    g = _sigmoid((x * gate_w).sum(-1, keepdims=True))
    a = _A_ref(x, A_A_re, A_A_im, A_B_re, A_B_im, A_C_re, A_C_im, A_log_dt, A_Dskip)
    b = _B_ref(x, B_wqkv, B_wo)
    return g * a + (1 - g) * b
```

```asm
; @launch grid=(256,1,1) block=(512,1,1) lds=163840
.amdgcn_target "amdgcn-amd-amdhsa--gfx950"
.text
.globl gated_mix__ssm_conv_s4__linear_attn_block__prompt_kernel
.p2align 8
.type gated_mix__ssm_conv_s4__linear_attn_block__prompt_kernel,@function
gated_mix__ssm_conv_s4__linear_attn_block__prompt_kernel:
s_cmp_ge_u32 s2, 256
s_cbranch_scc1 LK_end
s_load_dwordx16 s[32:47], s[0:1], 0
s_load_dwordx16 s[48:63], s[0:1], 64
s_getpc_b64 s[6:7]
CPF_pc_gated_mix__ssm_conv_s4__linear_attn_block__prompt_kernel:
s_sub_u32 s6, s6, CPF_pc_gated_mix__ssm_conv_s4__linear_attn_block__prompt_kernel-gated_mix__ssm_conv_s4__linear_attn_block__prompt_kernel
s_subb_u32 s7, s7, 0
s_lshr_b32 s4, s2, 3
s_lshl_b32 s4, s4, 10
v_lshlrev_b32 v2, 7, v0
v_add_u32 v2, s4, v2
v_min_u32 v2, KEND_gated_mix__ssm_conv_s4__linear_attn_block__prompt_kernel-gated_mix__ssm_conv_s4__linear_attn_block__prompt_kernel-4, v2
v_cmp_gt_u32 vcc, 8, v0
s_nop 1
s_and_saveexec_b64 s[64:65], vcc
s_cbranch_execz CPF_skip_gated_mix__ssm_conv_s4__linear_attn_block__prompt_kernel
global_load_dword v255, v2, s[6:7]
CPF_skip_gated_mix__ssm_conv_s4__linear_attn_block__prompt_kernel:
s_mov_b64 exec, s[64:65]
v_lshrrev_b32 v2, 6, v0
v_and_b32 v1, 63, v0
v_readfirstlane_b32 s5, v2
s_and_b32 s3, s2, 7
s_lshr_b32 s4, s2, 3
s_mov_b32 s10, 2097152
s_mov_b32 s11, 0x20000
s_mov_b32 s14, 1572864
s_mov_b32 s15, 0x20000
s_mov_b32 s18, 5832704
s_mov_b32 s19, 0x20000
s_mov_b32 s22, 1024
s_mov_b32 s23, 0x20000
s_mov_b32 s26, 524288
s_mov_b32 s27, 0x20000
s_mov_b32 s30, 2097152
s_mov_b32 s31, 0x20000
v_mov_b32 v2, 162816
v_mov_b32 v4, 0
v_mov_b32 v5, 0
v_mov_b32 v6, 0
v_mov_b32 v7, 0
ds_write_b128 v2, v[4:7]
s_cmp_ge_u32 s4, 16
s_cbranch_scc1 LK_conv
s_lshr_b32 s64, s3, 1
s_lshl_b32 s64, s64, 2
s_lshr_b32 s6, s4, 2
s_add_u32 s64, s64, s6
s_and_b32 s65, s3, 1
s_lshl_b32 s65, s65, 2
s_and_b32 s6, s4, 3
s_add_u32 s65, s65, s6
s_cmp_ge_u32 s5, 4
s_cbranch_scc1 LG_loader
s_and_b32 s66, s5, 1
s_lshr_b32 s67, s5, 1
v_and_b32 v8, 31, v1
v_lshrrev_b32 v9, 5, v1
v_lshrrev_b32 v10, 1, v8
v_and_b32 v10, 7, v10
v_lshlrev_b32 v11, 7, v8
s_lshl_b32 s6, s66, 13
v_add_u32 v11, s6, v11
v_add_u32 v12, 0, v9
v_xor_b32 v12, v12, v10
v_lshlrev_b32 v12, 4, v12
v_add_u32 v2, v11, v12
v_add_u32 v28, 81920, v2
v_add_u32 v12, 2, v9
v_xor_b32 v12, v12, v10
v_lshlrev_b32 v12, 4, v12
v_add_u32 v3, v11, v12
v_add_u32 v29, 81920, v3
v_add_u32 v12, 4, v9
v_xor_b32 v12, v12, v10
v_lshlrev_b32 v12, 4, v12
v_add_u32 v4, v11, v12
v_add_u32 v30, 81920, v4
v_add_u32 v12, 6, v9
v_xor_b32 v12, v12, v10
v_lshlrev_b32 v12, 4, v12
v_add_u32 v5, v11, v12
v_add_u32 v31, 81920, v5
v_lshrrev_b32 v8, 5, v1
v_bfe_u32 v9, v1, 2, 2
v_lshlrev_b32 v10, 3, v8
v_add_u32 v10, v10, v9
v_lshlrev_b32 v10, 7, v10
v_bfe_u32 v11, v1, 4, 1
v_lshlrev_b32 v11, 1, v11
v_bfe_u32 v12, v1, 1, 1
v_add_u32 v11, v11, v12
s_lshl_b32 s6, s67, 2
v_add_u32 v11, s6, v11
v_lshrrev_b32 v12, 1, v9
v_lshlrev_b32 v12, 2, v12
v_xor_b32 v11, v11, v12
v_lshlrev_b32 v11, 4, v11
v_and_b32 v12, 1, v1
v_lshlrev_b32 v12, 3, v12
v_add_u32 v10, v10, v11
v_add_u32 v10, v10, v12
v_add_u32 v6, 32768, v10
v_add_u32 v7, 98304, v10
v_mov_b32 v32, 897988541
v_mov_b32 v33, 897988541
v_mov_b32 v34, 897988541
v_mov_b32 v35, 897988541
v_mov_b32 v36, 897988541
v_mov_b32 v37, 897988541
v_mov_b32 v38, 897988541
v_mov_b32 v39, 897988541
v_mov_b32 v40, 897988541
v_mov_b32 v41, 897988541
v_mov_b32 v42, 897988541
v_mov_b32 v43, 897988541
v_mov_b32 v44, 897988541
v_mov_b32 v45, 897988541
v_mov_b32 v46, 897988541
v_mov_b32 v47, 897988541
v_mov_b32 v48, 897988541
v_mov_b32 v49, 897988541
v_mov_b32 v50, 897988541
v_mov_b32 v51, 897988541
v_mov_b32 v52, 897988541
v_mov_b32 v53, 897988541
v_mov_b32 v54, 897988541
v_mov_b32 v55, 897988541
v_mov_b32 v56, 897988541
v_mov_b32 v57, 897988541
v_mov_b32 v58, 897988541
v_mov_b32 v59, 897988541
v_mov_b32 v60, 897988541
v_mov_b32 v61, 897988541
v_mov_b32 v62, 897988541
v_mov_b32 v63, 897988541
v_mov_b32 v64, 897988541
v_mov_b32 v65, 897988541
v_mov_b32 v66, 897988541
v_mov_b32 v67, 897988541
v_mov_b32 v68, 897988541
v_mov_b32 v69, 897988541
v_mov_b32 v70, 897988541
v_mov_b32 v71, 897988541
v_mov_b32 v72, 897988541
v_mov_b32 v73, 897988541
v_mov_b32 v74, 897988541
v_mov_b32 v75, 897988541
v_mov_b32 v76, 897988541
v_mov_b32 v77, 897988541
v_mov_b32 v78, 897988541
v_mov_b32 v79, 897988541
v_mov_b32 v80, 897988541
v_mov_b32 v81, 897988541
v_mov_b32 v82, 897988541
v_mov_b32 v83, 897988541
v_mov_b32 v84, 897988541
v_mov_b32 v85, 897988541
v_mov_b32 v86, 897988541
v_mov_b32 v87, 897988541
v_mov_b32 v88, 897988541
v_mov_b32 v89, 897988541
v_mov_b32 v90, 897988541
v_mov_b32 v91, 897988541
v_mov_b32 v92, 897988541
v_mov_b32 v93, 897988541
v_mov_b32 v94, 897988541
v_mov_b32 v95, 897988541
s_mov_b32 s68, 1069066811
s_mov_b32 s69, 1069066811
s_mov_b32 s70, 897988541
v_mov_b32 v16, 0xb5c1a2a0
v_mov_b32 v17, 0xb5c1a2a0
s_waitcnt lgkmcnt(0)
s_mov_b32 s8, s32
s_mov_b32 s9, s33
s_mov_b32 s12, s52
s_mov_b32 s13, s53
s_mov_b32 s16, s62
s_mov_b32 s17, s63
s_mov_b32 s20, s56
s_mov_b32 s21, s57
s_mov_b32 s24, s54
s_mov_b32 s25, s55
s_mov_b32 s28, s58
s_mov_b32 s29, s59
s_barrier
ds_read_b128 v[128:131], v2 offset:0
ds_read_b64_tr_b16 v[136:137], v6 offset:0
ds_read_b64_tr_b16 v[138:139], v6 offset:512
ds_read_b64_tr_b16 v[140:141], v6 offset:8192
ds_read_b64_tr_b16 v[142:143], v6 offset:8704
ds_read_b64_tr_b16 v[144:145], v6 offset:16384
ds_read_b64_tr_b16 v[146:147], v6 offset:16896
ds_read_b128 v[132:135], v2 offset:4096
s_waitcnt lgkmcnt(3)
v_mfma_f32_32x32x16_bf16 v[64:79], v[128:131], v[140:143], v[64:79]
ds_read_b128 v[148:151], v3 offset:0
ds_read_b64_tr_b16 v[156:157], v6 offset:2048
ds_read_b64_tr_b16 v[158:159], v6 offset:2560
s_waitcnt lgkmcnt(4)
v_mfma_f32_32x32x16_bf16 v[96:111], v[128:131], v[144:147], 0
ds_read_b64_tr_b16 v[160:161], v6 offset:10240
ds_read_b64_tr_b16 v[162:163], v6 offset:10752
v_mfma_f32_32x32x16_bf16 v[32:47], v[136:139], v[128:131], v[32:47]
ds_read_b64_tr_b16 v[164:165], v6 offset:18432
ds_read_b64_tr_b16 v[166:167], v6 offset:18944
s_waitcnt lgkmcnt(7)
v_mfma_f32_32x32x16_bf16 v[80:95], v[132:135], v[140:143], v[80:95]
ds_read_b128 v[152:155], v3 offset:4096
v_mfma_f32_32x32x16_bf16 v[112:127], v[132:135], v[144:147], 0
v_mfma_f32_32x32x16_bf16 v[48:63], v[136:139], v[132:135], v[48:63]
s_waitcnt lgkmcnt(3)
v_mfma_f32_32x32x16_bf16 v[64:79], v[148:151], v[160:163], v[64:79]
ds_read_b128 v[128:131], v4 offset:0
ds_read_b64_tr_b16 v[136:137], v6 offset:4096
ds_read_b64_tr_b16 v[138:139], v6 offset:4608
s_waitcnt lgkmcnt(4)
v_mfma_f32_32x32x16_bf16 v[96:111], v[148:151], v[164:167], v[96:111]
ds_read_b64_tr_b16 v[140:141], v6 offset:12288
ds_read_b64_tr_b16 v[142:143], v6 offset:12800
v_mfma_f32_32x32x16_bf16 v[32:47], v[156:159], v[148:151], v[32:47]
ds_read_b64_tr_b16 v[144:145], v6 offset:20480
ds_read_b64_tr_b16 v[146:147], v6 offset:20992
s_waitcnt lgkmcnt(7)
v_mfma_f32_32x32x16_bf16 v[80:95], v[152:155], v[160:163], v[80:95]
ds_read_b128 v[132:135], v4 offset:4096
v_mfma_f32_32x32x16_bf16 v[112:127], v[152:155], v[164:167], v[112:127]
v_mfma_f32_32x32x16_bf16 v[48:63], v[156:159], v[152:155], v[48:63]
s_waitcnt lgkmcnt(3)
v_mfma_f32_32x32x16_bf16 v[64:79], v[128:131], v[140:143], v[64:79]
ds_read_b128 v[148:151], v5 offset:0
ds_read_b64_tr_b16 v[156:157], v6 offset:6144
ds_read_b64_tr_b16 v[158:159], v6 offset:6656
s_waitcnt lgkmcnt(4)
v_mfma_f32_32x32x16_bf16 v[96:111], v[128:131], v[144:147], v[96:111]
ds_read_b64_tr_b16 v[160:161], v6 offset:14336
ds_read_b64_tr_b16 v[162:163], v6 offset:14848
v_mfma_f32_32x32x16_bf16 v[32:47], v[136:139], v[128:131], v[32:47]
ds_read_b64_tr_b16 v[164:165], v6 offset:22528
ds_read_b64_tr_b16 v[166:167], v6 offset:23040
s_waitcnt lgkmcnt(7)
v_mfma_f32_32x32x16_bf16 v[80:95], v[132:135], v[140:143], v[80:95]
ds_read_b128 v[152:155], v5 offset:4096
v_mfma_f32_32x32x16_bf16 v[112:127], v[132:135], v[144:147], v[112:127]
v_mfma_f32_32x32x16_bf16 v[48:63], v[136:139], v[132:135], v[48:63]
s_waitcnt lgkmcnt(3)
v_mfma_f32_32x32x16_bf16 v[64:79], v[148:151], v[160:163], v[64:79]
s_waitcnt lgkmcnt(0)
s_barrier
ds_read_b128 v[128:131], v28 offset:0
ds_read_b64_tr_b16 v[136:137], v7 offset:0
ds_read_b64_tr_b16 v[138:139], v7 offset:512
v_mfma_f32_32x32x16_bf16 v[96:111], v[148:151], v[164:167], v[96:111]
ds_read_b64_tr_b16 v[140:141], v7 offset:8192
ds_read_b64_tr_b16 v[142:143], v7 offset:8704
v_mfma_f32_32x32x16_bf16 v[32:47], v[156:159], v[148:151], v[32:47]
ds_read_b64_tr_b16 v[144:145], v7 offset:16384
ds_read_b64_tr_b16 v[146:147], v7 offset:16896
v_mfma_f32_32x32x16_bf16 v[80:95], v[152:155], v[160:163], v[80:95]
ds_read_b128 v[132:135], v28 offset:4096
v_mfma_f32_32x32x16_bf16 v[112:127], v[152:155], v[164:167], v[112:127]
v_mfma_f32_32x32x16_bf16 v[48:63], v[156:159], v[152:155], v[48:63]
s_waitcnt lgkmcnt(3)
v_mfma_f32_32x32x16_bf16 v[64:79], v[128:131], v[140:143], v[64:79]
ds_read_b128 v[148:151], v29 offset:0
ds_read_b64_tr_b16 v[156:157], v7 offset:2048
ds_read_b64_tr_b16 v[158:159], v7 offset:2560
s_waitcnt lgkmcnt(4)
v_mfma_f32_32x32x16_bf16 v[96:111], v[128:131], v[144:147], v[96:111]
ds_read_b64_tr_b16 v[160:161], v7 offset:10240
ds_read_b64_tr_b16 v[162:163], v7 offset:10752
v_mfma_f32_32x32x16_bf16 v[32:47], v[136:139], v[128:131], v[32:47]
ds_read_b64_tr_b16 v[164:165], v7 offset:18432
ds_read_b64_tr_b16 v[166:167], v7 offset:18944
s_waitcnt lgkmcnt(7)
v_mfma_f32_32x32x16_bf16 v[80:95], v[132:135], v[140:143], v[80:95]
ds_read_b128 v[152:155], v29 offset:4096
v_mfma_f32_32x32x16_bf16 v[112:127], v[132:135], v[144:147], v[112:127]
v_mfma_f32_32x32x16_bf16 v[48:63], v[136:139], v[132:135], v[48:63]
s_waitcnt lgkmcnt(3)
v_mfma_f32_32x32x16_bf16 v[64:79], v[148:151], v[160:163], v[64:79]
ds_read_b128 v[128:131], v30 offset:0
ds_read_b64_tr_b16 v[136:137], v7 offset:4096
ds_read_b64_tr_b16 v[138:139], v7 offset:4608
s_waitcnt lgkmcnt(4)
v_mfma_f32_32x32x16_bf16 v[96:111], v[148:151], v[164:167], v[96:111]
ds_read_b64_tr_b16 v[140:141], v7 offset:12288
ds_read_b64_tr_b16 v[142:143], v7 offset:12800
v_mfma_f32_32x32x16_bf16 v[32:47], v[156:159], v[148:151], v[32:47]
ds_read_b64_tr_b16 v[144:145], v7 offset:20480
ds_read_b64_tr_b16 v[146:147], v7 offset:20992
s_waitcnt lgkmcnt(7)
v_mfma_f32_32x32x16_bf16 v[80:95], v[152:155], v[160:163], v[80:95]
ds_read_b128 v[132:135], v30 offset:4096
v_mfma_f32_32x32x16_bf16 v[112:127], v[152:155], v[164:167], v[112:127]
v_mfma_f32_32x32x16_bf16 v[48:63], v[156:159], v[152:155], v[48:63]
s_waitcnt lgkmcnt(3)
v_mfma_f32_32x32x16_bf16 v[64:79], v[128:131], v[140:143], v[64:79]
ds_read_b128 v[148:151], v31 offset:0
ds_read_b64_tr_b16 v[156:157], v7 offset:6144
ds_read_b64_tr_b16 v[158:159], v7 offset:6656
s_waitcnt lgkmcnt(4)
v_mfma_f32_32x32x16_bf16 v[96:111], v[128:131], v[144:147], v[96:111]
ds_read_b64_tr_b16 v[160:161], v7 offset:14336
ds_read_b64_tr_b16 v[162:163], v7 offset:14848
v_mfma_f32_32x32x16_bf16 v[32:47], v[136:139], v[128:131], v[32:47]
ds_read_b64_tr_b16 v[164:165], v7 offset:22528
ds_read_b64_tr_b16 v[166:167], v7 offset:23040
s_waitcnt lgkmcnt(7)
v_mfma_f32_32x32x16_bf16 v[80:95], v[132:135], v[140:143], v[80:95]
ds_read_b128 v[152:155], v31 offset:4096
v_mfma_f32_32x32x16_bf16 v[112:127], v[132:135], v[144:147], v[112:127]
v_mfma_f32_32x32x16_bf16 v[48:63], v[136:139], v[132:135], v[48:63]
s_waitcnt lgkmcnt(3)
v_mfma_f32_32x32x16_bf16 v[64:79], v[148:151], v[160:163], v[64:79]
s_waitcnt lgkmcnt(0)
s_barrier
ds_read_b128 v[128:131], v2 offset:16384
ds_read_b64_tr_b16 v[136:137], v6 offset:24576
ds_read_b64_tr_b16 v[138:139], v6 offset:25088
v_mfma_f32_32x32x16_bf16 v[96:111], v[148:151], v[164:167], v[96:111]
ds_read_b64_tr_b16 v[140:141], v6 offset:32768
ds_read_b64_tr_b16 v[142:143], v6 offset:33280
v_mfma_f32_32x32x16_bf16 v[32:47], v[156:159], v[148:151], v[32:47]
ds_read_b64_tr_b16 v[144:145], v6 offset:40960
ds_read_b64_tr_b16 v[146:147], v6 offset:41472
v_mfma_f32_32x32x16_bf16 v[80:95], v[152:155], v[160:163], v[80:95]
ds_read_b128 v[132:135], v2 offset:20480
v_mfma_f32_32x32x16_bf16 v[112:127], v[152:155], v[164:167], v[112:127]
v_mfma_f32_32x32x16_bf16 v[48:63], v[156:159], v[152:155], v[48:63]
s_waitcnt lgkmcnt(3)
v_mfma_f32_32x32x16_bf16 v[64:79], v[128:131], v[140:143], v[64:79]
ds_read_b128 v[148:151], v3 offset:16384
ds_read_b64_tr_b16 v[156:157], v6 offset:26624
ds_read_b64_tr_b16 v[158:159], v6 offset:27136
s_waitcnt lgkmcnt(4)
v_mfma_f32_32x32x16_bf16 v[96:111], v[128:131], v[144:147], v[96:111]
ds_read_b64_tr_b16 v[160:161], v6 offset:34816
ds_read_b64_tr_b16 v[162:163], v6 offset:35328
v_mfma_f32_32x32x16_bf16 v[32:47], v[136:139], v[128:131], v[32:47]
ds_read_b64_tr_b16 v[164:165], v6 offset:43008
ds_read_b64_tr_b16 v[166:167], v6 offset:43520
s_waitcnt lgkmcnt(7)
v_mfma_f32_32x32x16_bf16 v[80:95], v[132:135], v[140:143], v[80:95]
ds_read_b128 v[152:155], v3 offset:20480
v_mfma_f32_32x32x16_bf16 v[112:127], v[132:135], v[144:147], v[112:127]
v_mfma_f32_32x32x16_bf16 v[48:63], v[136:139], v[132:135], v[48:63]
s_waitcnt lgkmcnt(3)
v_mfma_f32_32x32x16_bf16 v[64:79], v[148:151], v[160:163], v[64:79]
ds_read_b128 v[128:131], v4 offset:16384
ds_read_b64_tr_b16 v[136:137], v6 offset:28672
ds_read_b64_tr_b16 v[138:139], v6 offset:29184
s_waitcnt lgkmcnt(4)
v_mfma_f32_32x32x16_bf16 v[96:111], v[148:151], v[164:167], v[96:111]
ds_read_b64_tr_b16 v[140:141], v6 offset:36864
ds_read_b64_tr_b16 v[142:143], v6 offset:37376
v_mfma_f32_32x32x16_bf16 v[32:47], v[156:159], v[148:151], v[32:47]
ds_read_b64_tr_b16 v[144:145], v6 offset:45056
ds_read_b64_tr_b16 v[146:147], v6 offset:45568
s_waitcnt lgkmcnt(7)
v_mfma_f32_32x32x16_bf16 v[80:95], v[152:155], v[160:163], v[80:95]
ds_read_b128 v[132:135], v4 offset:20480
v_mfma_f32_32x32x16_bf16 v[112:127], v[152:155], v[164:167], v[112:127]
v_mfma_f32_32x32x16_bf16 v[48:63], v[156:159], v[152:155], v[48:63]
s_waitcnt lgkmcnt(3)
v_mfma_f32_32x32x16_bf16 v[64:79], v[128:131], v[140:143], v[64:79]
ds_read_b128 v[148:151], v5 offset:16384
ds_read_b64_tr_b16 v[156:157], v6 offset:30720
ds_read_b64_tr_b16 v[158:159], v6 offset:31232
s_waitcnt lgkmcnt(4)
v_mfma_f32_32x32x16_bf16 v[96:111], v[128:131], v[144:147], v[96:111]
ds_read_b64_tr_b16 v[160:161], v6 offset:38912
ds_read_b64_tr_b16 v[162:163], v6 offset:39424
v_mfma_f32_32x32x16_bf16 v[32:47], v[136:139], v[128:131], v[32:47]
ds_read_b64_tr_b16 v[164:165], v6 offset:47104
ds_read_b64_tr_b16 v[166:167], v6 offset:47616
s_waitcnt lgkmcnt(7)
v_mfma_f32_32x32x16_bf16 v[80:95], v[132:135], v[140:143], v[80:95]
ds_read_b128 v[152:155], v5 offset:20480
v_mfma_f32_32x32x16_bf16 v[112:127], v[132:135], v[144:147], v[112:127]
v_mfma_f32_32x32x16_bf16 v[48:63], v[136:139], v[132:135], v[48:63]
s_waitcnt lgkmcnt(3)
v_mfma_f32_32x32x16_bf16 v[64:79], v[148:151], v[160:163], v[64:79]
s_waitcnt lgkmcnt(0)
s_barrier
ds_read_b128 v[128:131], v2 offset:0
ds_read_b64_tr_b16 v[136:137], v6 offset:0
ds_read_b64_tr_b16 v[138:139], v6 offset:512
v_mfma_f32_32x32x16_bf16 v[96:111], v[148:151], v[164:167], v[96:111]
ds_read_b64_tr_b16 v[140:141], v6 offset:8192
ds_read_b64_tr_b16 v[142:143], v6 offset:8704
v_mfma_f32_32x32x16_bf16 v[32:47], v[156:159], v[148:151], v[32:47]
ds_read_b64_tr_b16 v[144:145], v6 offset:16384
ds_read_b64_tr_b16 v[146:147], v6 offset:16896
v_mfma_f32_32x32x16_bf16 v[80:95], v[152:155], v[160:163], v[80:95]
ds_read_b128 v[132:135], v2 offset:4096
v_mfma_f32_32x32x16_bf16 v[112:127], v[152:155], v[164:167], v[112:127]
v_mfma_f32_32x32x16_bf16 v[48:63], v[156:159], v[152:155], v[48:63]
s_waitcnt lgkmcnt(3)
v_mfma_f32_32x32x16_bf16 v[64:79], v[128:131], v[140:143], v[64:79]
ds_read_b128 v[148:151], v3 offset:0
ds_read_b64_tr_b16 v[156:157], v6 offset:2048
ds_read_b64_tr_b16 v[158:159], v6 offset:2560
s_waitcnt lgkmcnt(4)
v_mfma_f32_32x32x16_bf16 v[96:111], v[128:131], v[144:147], v[96:111]
ds_read_b64_tr_b16 v[160:161], v6 offset:10240
ds_read_b64_tr_b16 v[162:163], v6 offset:10752
v_mfma_f32_32x32x16_bf16 v[32:47], v[136:139], v[128:131], v[32:47]
ds_read_b64_tr_b16 v[164:165], v6 offset:18432
ds_read_b64_tr_b16 v[166:167], v6 offset:18944
s_waitcnt lgkmcnt(7)
v_mfma_f32_32x32x16_bf16 v[80:95], v[132:135], v[140:143], v[80:95]
ds_read_b128 v[152:155], v3 offset:4096
v_mfma_f32_32x32x16_bf16 v[112:127], v[132:135], v[144:147], v[112:127]
v_mfma_f32_32x32x16_bf16 v[48:63], v[136:139], v[132:135], v[48:63]
s_waitcnt lgkmcnt(3)
v_mfma_f32_32x32x16_bf16 v[64:79], v[148:151], v[160:163], v[64:79]
ds_read_b128 v[128:131], v4 offset:0
ds_read_b64_tr_b16 v[136:137], v6 offset:4096
ds_read_b64_tr_b16 v[138:139], v6 offset:4608
s_waitcnt lgkmcnt(4)
v_mfma_f32_32x32x16_bf16 v[96:111], v[148:151], v[164:167], v[96:111]
ds_read_b64_tr_b16 v[140:141], v6 offset:12288
ds_read_b64_tr_b16 v[142:143], v6 offset:12800
v_mfma_f32_32x32x16_bf16 v[32:47], v[156:159], v[148:151], v[32:47]
ds_read_b64_tr_b16 v[144:145], v6 offset:20480
ds_read_b64_tr_b16 v[146:147], v6 offset:20992
s_waitcnt lgkmcnt(7)
v_mfma_f32_32x32x16_bf16 v[80:95], v[152:155], v[160:163], v[80:95]
ds_read_b128 v[132:135], v4 offset:4096
v_mfma_f32_32x32x16_bf16 v[112:127], v[152:155], v[164:167], v[112:127]
v_mfma_f32_32x32x16_bf16 v[48:63], v[156:159], v[152:155], v[48:63]
s_waitcnt lgkmcnt(3)
v_mfma_f32_32x32x16_bf16 v[64:79], v[128:131], v[140:143], v[64:79]
ds_read_b128 v[148:151], v5 offset:0
ds_read_b64_tr_b16 v[156:157], v6 offset:6144
ds_read_b64_tr_b16 v[158:159], v6 offset:6656
s_waitcnt lgkmcnt(4)
v_mfma_f32_32x32x16_bf16 v[96:111], v[128:131], v[144:147], v[96:111]
ds_read_b64_tr_b16 v[160:161], v6 offset:14336
ds_read_b64_tr_b16 v[162:163], v6 offset:14848
v_mfma_f32_32x32x16_bf16 v[32:47], v[136:139], v[128:131], v[32:47]
ds_read_b64_tr_b16 v[164:165], v6 offset:22528
ds_read_b64_tr_b16 v[166:167], v6 offset:23040
s_waitcnt lgkmcnt(7)
v_mfma_f32_32x32x16_bf16 v[80:95], v[132:135], v[140:143], v[80:95]
ds_read_b128 v[152:155], v5 offset:4096
v_mfma_f32_32x32x16_bf16 v[112:127], v[132:135], v[144:147], v[112:127]
v_mfma_f32_32x32x16_bf16 v[48:63], v[136:139], v[132:135], v[48:63]
s_waitcnt lgkmcnt(3)
v_mfma_f32_32x32x16_bf16 v[64:79], v[148:151], v[160:163], v[64:79]
s_waitcnt lgkmcnt(0)
s_barrier
ds_read_b128 v[128:131], v28 offset:0
ds_read_b64_tr_b16 v[136:137], v7 offset:0
ds_read_b64_tr_b16 v[138:139], v7 offset:512
v_mfma_f32_32x32x16_bf16 v[96:111], v[148:151], v[164:167], v[96:111]
ds_read_b64_tr_b16 v[140:141], v7 offset:8192
ds_read_b64_tr_b16 v[142:143], v7 offset:8704
v_mfma_f32_32x32x16_bf16 v[32:47], v[156:159], v[148:151], v[32:47]
ds_read_b64_tr_b16 v[144:145], v7 offset:16384
ds_read_b64_tr_b16 v[146:147], v7 offset:16896
v_mfma_f32_32x32x16_bf16 v[80:95], v[152:155], v[160:163], v[80:95]
ds_read_b128 v[132:135], v28 offset:4096
v_mfma_f32_32x32x16_bf16 v[112:127], v[152:155], v[164:167], v[112:127]
v_mfma_f32_32x32x16_bf16 v[48:63], v[156:159], v[152:155], v[48:63]
s_waitcnt lgkmcnt(3)
v_mfma_f32_32x32x16_bf16 v[64:79], v[128:131], v[140:143], v[64:79]
ds_read_b128 v[148:151], v29 offset:0
ds_read_b64_tr_b16 v[156:157], v7 offset:2048
ds_read_b64_tr_b16 v[158:159], v7 offset:2560
s_waitcnt lgkmcnt(4)
v_mfma_f32_32x32x16_bf16 v[96:111], v[128:131], v[144:147], v[96:111]
ds_read_b64_tr_b16 v[160:161], v7 offset:10240
ds_read_b64_tr_b16 v[162:163], v7 offset:10752
v_mfma_f32_32x32x16_bf16 v[32:47], v[136:139], v[128:131], v[32:47]
ds_read_b64_tr_b16 v[164:165], v7 offset:18432
ds_read_b64_tr_b16 v[166:167], v7 offset:18944
s_waitcnt lgkmcnt(7)
v_mfma_f32_32x32x16_bf16 v[80:95], v[132:135], v[140:143], v[80:95]
ds_read_b128 v[152:155], v29 offset:4096
v_mfma_f32_32x32x16_bf16 v[112:127], v[132:135], v[144:147], v[112:127]
v_mfma_f32_32x32x16_bf16 v[48:63], v[136:139], v[132:135], v[48:63]
s_waitcnt lgkmcnt(3)
v_mfma_f32_32x32x16_bf16 v[64:79], v[148:151], v[160:163], v[64:79]
ds_read_b128 v[128:131], v30 offset:0
ds_read_b64_tr_b16 v[136:137], v7 offset:4096
ds_read_b64_tr_b16 v[138:139], v7 offset:4608
s_waitcnt lgkmcnt(4)
v_mfma_f32_32x32x16_bf16 v[96:111], v[148:151], v[164:167], v[96:111]
ds_read_b64_tr_b16 v[140:141], v7 offset:12288
ds_read_b64_tr_b16 v[142:143], v7 offset:12800
v_mfma_f32_32x32x16_bf16 v[32:47], v[156:159], v[148:151], v[32:47]
ds_read_b64_tr_b16 v[144:145], v7 offset:20480
ds_read_b64_tr_b16 v[146:147], v7 offset:20992
s_waitcnt lgkmcnt(7)
v_mfma_f32_32x32x16_bf16 v[80:95], v[152:155], v[160:163], v[80:95]
ds_read_b128 v[132:135], v30 offset:4096
v_mfma_f32_32x32x16_bf16 v[112:127], v[152:155], v[164:167], v[112:127]
v_mfma_f32_32x32x16_bf16 v[48:63], v[156:159], v[152:155], v[48:63]
s_waitcnt lgkmcnt(3)
v_mfma_f32_32x32x16_bf16 v[64:79], v[128:131], v[140:143], v[64:79]
ds_read_b128 v[148:151], v31 offset:0
ds_read_b64_tr_b16 v[156:157], v7 offset:6144
ds_read_b64_tr_b16 v[158:159], v7 offset:6656
s_waitcnt lgkmcnt(4)
v_mfma_f32_32x32x16_bf16 v[96:111], v[128:131], v[144:147], v[96:111]
ds_read_b64_tr_b16 v[160:161], v7 offset:14336
ds_read_b64_tr_b16 v[162:163], v7 offset:14848
v_mfma_f32_32x32x16_bf16 v[32:47], v[136:139], v[128:131], v[32:47]
ds_read_b64_tr_b16 v[164:165], v7 offset:22528
ds_read_b64_tr_b16 v[166:167], v7 offset:23040
s_waitcnt lgkmcnt(7)
v_mfma_f32_32x32x16_bf16 v[80:95], v[132:135], v[140:143], v[80:95]
ds_read_b128 v[152:155], v31 offset:4096
v_mfma_f32_32x32x16_bf16 v[112:127], v[132:135], v[144:147], v[112:127]
v_mfma_f32_32x32x16_bf16 v[48:63], v[136:139], v[132:135], v[48:63]
s_waitcnt lgkmcnt(3)
v_mfma_f32_32x32x16_bf16 v[64:79], v[148:151], v[160:163], v[64:79]
s_waitcnt lgkmcnt(0)
s_barrier
ds_read_b128 v[128:131], v2 offset:16384
ds_read_b64_tr_b16 v[136:137], v6 offset:24576
ds_read_b64_tr_b16 v[138:139], v6 offset:25088
v_mfma_f32_32x32x16_bf16 v[96:111], v[148:151], v[164:167], v[96:111]
ds_read_b64_tr_b16 v[140:141], v6 offset:32768
ds_read_b64_tr_b16 v[142:143], v6 offset:33280
v_mfma_f32_32x32x16_bf16 v[32:47], v[156:159], v[148:151], v[32:47]
ds_read_b64_tr_b16 v[144:145], v6 offset:40960
ds_read_b64_tr_b16 v[146:147], v6 offset:41472
v_mfma_f32_32x32x16_bf16 v[80:95], v[152:155], v[160:163], v[80:95]
ds_read_b128 v[132:135], v2 offset:20480
v_mfma_f32_32x32x16_bf16 v[112:127], v[152:155], v[164:167], v[112:127]
v_mfma_f32_32x32x16_bf16 v[48:63], v[156:159], v[152:155], v[48:63]
s_waitcnt lgkmcnt(3)
v_mfma_f32_32x32x16_bf16 v[64:79], v[128:131], v[140:143], v[64:79]
ds_read_b128 v[148:151], v3 offset:16384
ds_read_b64_tr_b16 v[156:157], v6 offset:26624
ds_read_b64_tr_b16 v[158:159], v6 offset:27136
s_waitcnt lgkmcnt(4)
v_mfma_f32_32x32x16_bf16 v[96:111], v[128:131], v[144:147], v[96:111]
ds_read_b64_tr_b16 v[160:161], v6 offset:34816
ds_read_b64_tr_b16 v[162:163], v6 offset:35328
v_mfma_f32_32x32x16_bf16 v[32:47], v[136:139], v[128:131], v[32:47]
ds_read_b64_tr_b16 v[164:165], v6 offset:43008
ds_read_b64_tr_b16 v[166:167], v6 offset:43520
s_waitcnt lgkmcnt(7)
v_mfma_f32_32x32x16_bf16 v[80:95], v[132:135], v[140:143], v[80:95]
ds_read_b128 v[152:155], v3 offset:20480
v_mfma_f32_32x32x16_bf16 v[112:127], v[132:135], v[144:147], v[112:127]
v_mfma_f32_32x32x16_bf16 v[48:63], v[136:139], v[132:135], v[48:63]
s_waitcnt lgkmcnt(3)
v_mfma_f32_32x32x16_bf16 v[64:79], v[148:151], v[160:163], v[64:79]
ds_read_b128 v[128:131], v4 offset:16384
ds_read_b64_tr_b16 v[136:137], v6 offset:28672
ds_read_b64_tr_b16 v[138:139], v6 offset:29184
s_waitcnt lgkmcnt(4)
v_mfma_f32_32x32x16_bf16 v[96:111], v[148:151], v[164:167], v[96:111]
ds_read_b64_tr_b16 v[140:141], v6 offset:36864
ds_read_b64_tr_b16 v[142:143], v6 offset:37376
v_mfma_f32_32x32x16_bf16 v[32:47], v[156:159], v[148:151], v[32:47]
ds_read_b64_tr_b16 v[144:145], v6 offset:45056
ds_read_b64_tr_b16 v[146:147], v6 offset:45568
s_waitcnt lgkmcnt(7)
v_mfma_f32_32x32x16_bf16 v[80:95], v[152:155], v[160:163], v[80:95]
ds_read_b128 v[132:135], v4 offset:20480
v_mfma_f32_32x32x16_bf16 v[112:127], v[152:155], v[164:167], v[112:127]
v_mfma_f32_32x32x16_bf16 v[48:63], v[156:159], v[152:155], v[48:63]
s_waitcnt lgkmcnt(3)
v_mfma_f32_32x32x16_bf16 v[64:79], v[128:131], v[140:143], v[64:79]
ds_read_b128 v[148:151], v5 offset:16384
ds_read_b64_tr_b16 v[156:157], v6 offset:30720
ds_read_b64_tr_b16 v[158:159], v6 offset:31232
s_waitcnt lgkmcnt(4)
v_mfma_f32_32x32x16_bf16 v[96:111], v[128:131], v[144:147], v[96:111]
ds_read_b64_tr_b16 v[160:161], v6 offset:38912
ds_read_b64_tr_b16 v[162:163], v6 offset:39424
v_mfma_f32_32x32x16_bf16 v[32:47], v[136:139], v[128:131], v[32:47]
ds_read_b64_tr_b16 v[164:165], v6 offset:47104
ds_read_b64_tr_b16 v[166:167], v6 offset:47616
s_waitcnt lgkmcnt(7)
v_mfma_f32_32x32x16_bf16 v[80:95], v[132:135], v[140:143], v[80:95]
ds_read_b128 v[152:155], v5 offset:20480
v_mfma_f32_32x32x16_bf16 v[112:127], v[132:135], v[144:147], v[112:127]
v_mfma_f32_32x32x16_bf16 v[48:63], v[136:139], v[132:135], v[48:63]
s_waitcnt lgkmcnt(3)
v_mfma_f32_32x32x16_bf16 v[64:79], v[148:151], v[160:163], v[64:79]
s_waitcnt lgkmcnt(0)
s_barrier
ds_read_b128 v[128:131], v2 offset:0
ds_read_b64_tr_b16 v[136:137], v6 offset:0
ds_read_b64_tr_b16 v[138:139], v6 offset:512
v_mfma_f32_32x32x16_bf16 v[96:111], v[148:151], v[164:167], v[96:111]
ds_read_b64_tr_b16 v[140:141], v6 offset:8192
ds_read_b64_tr_b16 v[142:143], v6 offset:8704
v_mfma_f32_32x32x16_bf16 v[32:47], v[156:159], v[148:151], v[32:47]
ds_read_b64_tr_b16 v[144:145], v6 offset:16384
ds_read_b64_tr_b16 v[146:147], v6 offset:16896
v_mfma_f32_32x32x16_bf16 v[80:95], v[152:155], v[160:163], v[80:95]
ds_read_b128 v[132:135], v2 offset:4096
v_mfma_f32_32x32x16_bf16 v[112:127], v[152:155], v[164:167], v[112:127]
v_mfma_f32_32x32x16_bf16 v[48:63], v[156:159], v[152:155], v[48:63]
s_waitcnt lgkmcnt(3)
v_mfma_f32_32x32x16_bf16 v[64:79], v[128:131], v[140:143], v[64:79]
ds_read_b128 v[148:151], v3 offset:0
ds_read_b64_tr_b16 v[156:157], v6 offset:2048
ds_read_b64_tr_b16 v[158:159], v6 offset:2560
s_waitcnt lgkmcnt(4)
v_mfma_f32_32x32x16_bf16 v[96:111], v[128:131], v[144:147], v[96:111]
ds_read_b64_tr_b16 v[160:161], v6 offset:10240
ds_read_b64_tr_b16 v[162:163], v6 offset:10752
v_mfma_f32_32x32x16_bf16 v[32:47], v[136:139], v[128:131], v[32:47]
ds_read_b64_tr_b16 v[164:165], v6 offset:18432
ds_read_b64_tr_b16 v[166:167], v6 offset:18944
s_waitcnt lgkmcnt(7)
v_mfma_f32_32x32x16_bf16 v[80:95], v[132:135], v[140:143], v[80:95]
ds_read_b128 v[152:155], v3 offset:4096
v_mfma_f32_32x32x16_bf16 v[112:127], v[132:135], v[144:147], v[112:127]
v_mfma_f32_32x32x16_bf16 v[48:63], v[136:139], v[132:135], v[48:63]
v_mov_b32 v13, 0
global_load_dword v13, v13, s[60:61] sc1
s_waitcnt lgkmcnt(3)
v_mfma_f32_32x32x16_bf16 v[64:79], v[148:151], v[160:163], v[64:79]
ds_read_b128 v[128:131], v4 offset:0
ds_read_b64_tr_b16 v[136:137], v6 offset:4096
ds_read_b64_tr_b16 v[138:139], v6 offset:4608
s_waitcnt lgkmcnt(4)
v_mfma_f32_32x32x16_bf16 v[96:111], v[148:151], v[164:167], v[96:111]
ds_read_b64_tr_b16 v[140:141], v6 offset:12288
ds_read_b64_tr_b16 v[142:143], v6 offset:12800
v_mfma_f32_32x32x16_bf16 v[32:47], v[156:159], v[148:151], v[32:47]
ds_read_b64_tr_b16 v[144:145], v6 offset:20480
ds_read_b64_tr_b16 v[146:147], v6 offset:20992
s_waitcnt lgkmcnt(7)
v_mfma_f32_32x32x16_bf16 v[80:95], v[152:155], v[160:163], v[80:95]
ds_read_b128 v[132:135], v4 offset:4096
v_mfma_f32_32x32x16_bf16 v[112:127], v[152:155], v[164:167], v[112:127]
v_mfma_f32_32x32x16_bf16 v[48:63], v[156:159], v[152:155], v[48:63]
s_waitcnt lgkmcnt(3)
v_mfma_f32_32x32x16_bf16 v[64:79], v[128:131], v[140:143], v[64:79]
ds_read_b128 v[148:151], v5 offset:0
ds_read_b64_tr_b16 v[156:157], v6 offset:6144
ds_read_b64_tr_b16 v[158:159], v6 offset:6656
s_waitcnt lgkmcnt(4)
v_mfma_f32_32x32x16_bf16 v[96:111], v[128:131], v[144:147], v[96:111]
ds_read_b64_tr_b16 v[160:161], v6 offset:14336
ds_read_b64_tr_b16 v[162:163], v6 offset:14848
v_mfma_f32_32x32x16_bf16 v[32:47], v[136:139], v[128:131], v[32:47]
ds_read_b64_tr_b16 v[164:165], v6 offset:22528
ds_read_b64_tr_b16 v[166:167], v6 offset:23040
s_waitcnt lgkmcnt(7)
v_mfma_f32_32x32x16_bf16 v[80:95], v[132:135], v[140:143], v[80:95]
ds_read_b128 v[152:155], v5 offset:4096
v_mfma_f32_32x32x16_bf16 v[112:127], v[132:135], v[144:147], v[112:127]
v_mfma_f32_32x32x16_bf16 v[48:63], v[136:139], v[132:135], v[48:63]
s_waitcnt lgkmcnt(3)
v_mfma_f32_32x32x16_bf16 v[64:79], v[148:151], v[160:163], v[64:79]
s_waitcnt lgkmcnt(0)
s_barrier
v_mfma_f32_32x32x16_bf16 v[80:95], v[152:155], v[160:163], v[80:95]
ds_read_b128 v[168:171], v28 offset:0
ds_read_b128 v[172:175], v28 offset:4096
ds_read_b64_tr_b16 v[200:201], v7 offset:8192
ds_read_b64_tr_b16 v[202:203], v7 offset:8704
ds_read_b128 v[176:179], v29 offset:0
ds_read_b128 v[180:183], v29 offset:4096
ds_read_b64_tr_b16 v[204:205], v7 offset:10240
v_mfma_f32_32x32x16_bf16 v[96:111], v[148:151], v[164:167], v[96:111]
ds_read_b64_tr_b16 v[206:207], v7 offset:10752
ds_read_b128 v[184:187], v30 offset:0
ds_read_b128 v[188:191], v30 offset:4096
ds_read_b64_tr_b16 v[208:209], v7 offset:12288
ds_read_b64_tr_b16 v[210:211], v7 offset:12800
ds_read_b128 v[192:195], v31 offset:0
ds_read_b128 v[196:199], v31 offset:4096
v_mfma_f32_32x32x16_bf16 v[112:127], v[152:155], v[164:167], v[112:127]
ds_read_b64_tr_b16 v[212:213], v7 offset:14336
ds_read_b64_tr_b16 v[214:215], v7 offset:14848
ds_read_b64_tr_b16 v[216:217], v7 offset:16384
ds_read_b64_tr_b16 v[218:219], v7 offset:16896
ds_read_b64_tr_b16 v[220:221], v7 offset:18432
ds_read_b64_tr_b16 v[222:223], v7 offset:18944
ds_read_b64_tr_b16 v[224:225], v7 offset:20480
v_mfma_f32_32x32x16_bf16 v[32:47], v[156:159], v[148:151], v[32:47]
ds_read_b64_tr_b16 v[226:227], v7 offset:20992
ds_read_b64_tr_b16 v[228:229], v7 offset:22528
ds_read_b64_tr_b16 v[230:231], v7 offset:23040
v_and_b32 v8, 16, v1
v_cmp_eq_u32 vcc, 0, v8
ds_read_b64_tr_b16 v[232:233], v7 offset:0
ds_read_b64_tr_b16 v[234:235], v7 offset:512
v_mfma_f32_32x32x16_bf16 v[48:63], v[156:159], v[152:155], v[48:63]
ds_read_b64_tr_b16 v[236:237], v7 offset:2048
ds_read_b64_tr_b16 v[238:239], v7 offset:2560
ds_read_b64_tr_b16 v[240:241], v7 offset:4096
ds_read_b64_tr_b16 v[242:243], v7 offset:4608
ds_read_b64_tr_b16 v[244:245], v7 offset:6144
ds_read_b64_tr_b16 v[246:247], v7 offset:6656
s_waitcnt lgkmcnt(15)
v_mfma_f32_32x32x16_bf16 v[64:79], v[168:171], v[200:203], v[64:79]
v_mfma_f32_32x32x16_bf16 v[80:95], v[172:175], v[200:203], v[80:95]
v_mfma_f32_32x32x16_bf16 v[64:79], v[176:179], v[204:207], v[64:79]
v_mfma_f32_32x32x16_bf16 v[80:95], v[180:183], v[204:207], v[80:95]
v_mfma_f32_32x32x16_bf16 v[64:79], v[184:187], v[208:211], v[64:79]
v_mfma_f32_32x32x16_bf16 v[80:95], v[188:191], v[208:211], v[80:95]
v_mfma_f32_32x32x16_bf16 v[64:79], v[192:195], v[212:215], v[64:79]
v_mfma_f32_32x32x16_bf16 v[80:95], v[196:199], v[212:215], v[80:95]
s_waitcnt lgkmcnt(14)
v_mfma_f32_32x32x16_bf16 v[96:111], v[168:171], v[216:219], v[96:111]
s_waitcnt lgkmcnt(12)
v_mfma_f32_32x32x16_bf16 v[96:111], v[176:179], v[220:223], v[96:111]
s_nop 6
v_fma_f32 v128, v64, s68, v16
v_fma_f32 v129, v65, s68, v16
v_fma_f32 v130, v66, s68, v16
v_fma_f32 v131, v67, s68, v16
v_fma_f32 v132, v68, s68, v16
v_fma_f32 v133, v69, s68, v16
v_fma_f32 v134, v70, s68, v16
v_mfma_f32_32x32x16_bf16 v[112:127], v[172:175], v[216:219], v[112:127]
v_fma_f32 v135, v71, s68, v16
v_fma_f32 v144, v80, s68, v16
v_fma_f32 v145, v81, s68, v16
v_fma_f32 v146, v82, s68, v16
v_fma_f32 v147, v83, s68, v16
v_exp_f32 v128, v128 clamp
s_waitcnt lgkmcnt(10)
v_mfma_f32_32x32x16_bf16 v[96:111], v[184:187], v[224:227], v[96:111]
v_exp_f32 v129, v129 clamp
v_exp_f32 v130, v130 clamp
v_exp_f32 v131, v131 clamp
v_exp_f32 v132, v132 clamp
v_mfma_f32_32x32x16_bf16 v[112:127], v[180:183], v[220:223], v[112:127]
v_exp_f32 v133, v133 clamp
v_exp_f32 v134, v134 clamp
v_exp_f32 v135, v135 clamp
v_fma_f32 v136, v72, s68, v16
s_waitcnt lgkmcnt(8)
v_mfma_f32_32x32x16_bf16 v[96:111], v[192:195], v[228:231], v[96:111]
v_fma_f32 v137, v73, s68, v16
v_fma_f32 v138, v74, s68, v16
v_fma_f32 v139, v75, s68, v16
v_fma_f32 v140, v76, s68, v16
v_fma_f32 v141, v77, s68, v16
v_fma_f32 v142, v78, s68, v16
v_fma_f32 v143, v79, s68, v16
v_mfma_f32_32x32x16_bf16 v[112:127], v[188:191], v[224:227], v[112:127]
v_exp_f32 v144, v144 clamp
v_exp_f32 v145, v145 clamp
v_exp_f32 v146, v146 clamp
v_exp_f32 v147, v147 clamp
v_mfma_f32_32x32x16_bf16 v[112:127], v[196:199], v[228:231], v[112:127]
v_fma_f32 v148, v84, s68, v16
v_fma_f32 v149, v85, s68, v16
v_fma_f32 v150, v86, s68, v16
v_fma_f32 v151, v87, s68, v16
v_exp_f32 v136, v136 clamp
v_exp_f32 v137, v137 clamp
v_exp_f32 v138, v138 clamp
v_exp_f32 v139, v139 clamp
v_exp_f32 v140, v140 clamp
v_exp_f32 v141, v141 clamp
v_exp_f32 v142, v142 clamp
v_exp_f32 v143, v143 clamp
v_exp_f32 v148, v148 clamp
v_exp_f32 v149, v149 clamp
v_exp_f32 v150, v150 clamp
v_exp_f32 v151, v151 clamp
v_fma_f32 v152, v88, s68, v16
v_fma_f32 v153, v89, s68, v16
v_fma_f32 v154, v90, s68, v16
v_fma_f32 v155, v91, s68, v16
v_exp_f32 v152, v152 clamp
v_exp_f32 v153, v153 clamp
v_exp_f32 v154, v154 clamp
v_exp_f32 v155, v155 clamp
v_fma_f32 v156, v92, s68, v16
v_fma_f32 v157, v93, s68, v16
v_fma_f32 v158, v94, s68, v16
v_fma_f32 v159, v95, s68, v16
v_max_f32 v64, s70, v64
v_max_f32 v65, s70, v65
v_max_f32 v66, s70, v66
v_max_f32 v67, s70, v67
v_max_f32 v68, s70, v68
v_max_f32 v69, s70, v69
v_max_f32 v70, s70, v70
v_max_f32 v71, s70, v71
v_max_f32 v80, s70, v80
v_max_f32 v81, s70, v81
v_max_f32 v82, s70, v82
v_max_f32 v83, s70, v83
v_exp_f32 v156, v156 clamp
v_exp_f32 v157, v157 clamp
v_exp_f32 v158, v158 clamp
v_exp_f32 v159, v159 clamp
v_add_f32 v64, v64, v128
v_add_f32 v65, v65, v129
v_add_f32 v66, v66, v130
v_add_f32 v67, v67, v131
v_add_f32 v68, v68, v132
v_add_f32 v69, v69, v133
v_add_f32 v70, v70, v134
v_add_f32 v71, v71, v135
v_max_f32 v72, s70, v72
v_max_f32 v73, s70, v73
v_max_f32 v74, s70, v74
v_max_f32 v75, s70, v75
v_max_f32 v76, s70, v76
v_max_f32 v77, s70, v77
v_max_f32 v78, s70, v78
v_max_f32 v79, s70, v79
v_add_f32 v80, v80, v144
v_add_f32 v81, v81, v145
v_add_f32 v82, v82, v146
v_add_f32 v83, v83, v147
v_max_f32 v84, s70, v84
v_max_f32 v85, s70, v85
v_max_f32 v86, s70, v86
v_max_f32 v87, s70, v87
v_add_f32 v72, v72, v136
v_add_f32 v73, v73, v137
v_add_f32 v74, v74, v138
v_add_f32 v75, v75, v139
v_add_f32 v76, v76, v140
v_add_f32 v77, v77, v141
v_add_f32 v78, v78, v142
v_add_f32 v79, v79, v143
v_add_f32 v84, v84, v148
v_add_f32 v85, v85, v149
v_add_f32 v86, v86, v150
v_add_f32 v87, v87, v151
v_max_f32 v88, s70, v88
v_max_f32 v89, s70, v89
v_max_f32 v90, s70, v90
v_max_f32 v91, s70, v91
v_cvt_pk_bf16_f32 v128, v64, v65
v_cvt_pk_bf16_f32 v144, v96, v97
v_cvt_pk_bf16_f32 v129, v66, v67
v_cvt_pk_bf16_f32 v145, v98, v99
v_cvt_pk_bf16_f32 v130, v68, v69
v_cvt_pk_bf16_f32 v146, v100, v101
v_cvt_pk_bf16_f32 v131, v70, v71
v_cvt_pk_bf16_f32 v147, v102, v103
v_add_f32 v88, v88, v152
v_add_f32 v89, v89, v153
v_add_f32 v90, v90, v154
v_add_f32 v91, v91, v155
v_max_f32 v92, s70, v92
v_max_f32 v93, s70, v93
v_max_f32 v94, s70, v94
v_max_f32 v95, s70, v95
v_cvt_pk_bf16_f32 v132, v72, v73
v_cvt_pk_bf16_f32 v148, v104, v105
v_cvt_pk_bf16_f32 v133, v74, v75
v_cvt_pk_bf16_f32 v149, v106, v107
v_cvt_pk_bf16_f32 v134, v76, v77
v_cvt_pk_bf16_f32 v150, v108, v109
v_cvt_pk_bf16_f32 v135, v78, v79
v_cvt_pk_bf16_f32 v151, v110, v111
v_mfma_f32_32x32x16_bf16 v[96:111], v[128:131], v[144:147], 0
v_add_f32 v92, v92, v156
v_add_f32 v93, v93, v157
v_add_f32 v94, v94, v158
v_add_f32 v95, v95, v159
v_cvt_pk_bf16_f32 v136, v80, v81
v_cvt_pk_bf16_f32 v152, v112, v113
v_cvt_pk_bf16_f32 v137, v82, v83
v_mfma_f32_32x32x16_bf16 v[96:111], v[132:135], v[148:151], v[96:111]
v_cvt_pk_bf16_f32 v153, v114, v115
v_cvt_pk_bf16_f32 v138, v84, v85
v_cvt_pk_bf16_f32 v154, v116, v117
v_cvt_pk_bf16_f32 v139, v86, v87
v_cvt_pk_bf16_f32 v155, v118, v119
v_cvt_pk_bf16_f32 v140, v88, v89
v_cvt_pk_bf16_f32 v156, v120, v121
v_mfma_f32_32x32x16_bf16 v[96:111], v[136:139], v[152:155], v[96:111]
v_cvt_pk_bf16_f32 v141, v90, v91
v_cvt_pk_bf16_f32 v157, v122, v123
v_cvt_pk_bf16_f32 v142, v92, v93
v_cvt_pk_bf16_f32 v158, v124, v125
v_cvt_pk_bf16_f32 v143, v94, v95
v_cvt_pk_bf16_f32 v159, v126, v127
v_add_f32 v18, v64, v65
v_add_f32 v19, v72, v73
v_mfma_f32_32x32x16_bf16 v[96:111], v[140:143], v[156:159], v[96:111]
v_add_f32 v20, v80, v81
v_add_f32 v21, v88, v89
v_add_f32 v18, v18, v66
v_add_f32 v19, v19, v74
v_add_f32 v20, v20, v82
v_add_f32 v21, v21, v90
v_add_f32 v18, v18, v67
v_add_f32 v19, v19, v75
v_add_f32 v20, v20, v83
v_add_f32 v21, v21, v91
v_add_f32 v18, v18, v68
v_add_f32 v19, v19, v76
v_add_f32 v20, v20, v84
v_add_f32 v21, v21, v92
v_add_f32 v18, v18, v69
v_add_f32 v19, v19, v77
v_add_f32 v20, v20, v85
v_add_f32 v21, v21, v93
v_add_f32 v18, v18, v70
v_add_f32 v19, v19, v78
v_add_f32 v20, v20, v86
v_add_f32 v21, v21, v94
v_add_f32 v18, v18, v71
v_add_f32 v19, v19, v79
v_add_f32 v20, v20, v87
v_add_f32 v21, v21, v95
v_add_f32 v18, v18, v19
v_add_f32 v20, v20, v21
v_add_f32 v18, v18, v20
v_mov_b32 v19, v18
v_cndmask_b32 v112, v104, v96, vcc
v_cndmask_b32 v113, v105, v97, vcc
v_permlane32_swap_b32 v18, v19
v_add_f32 v120, v18, v19
v_cndmask_b32 v114, v106, v98, vcc
v_cndmask_b32 v115, v107, v99, vcc
v_cndmask_b32 v116, v108, v100, vcc
v_cndmask_b32 v117, v109, v101, vcc
v_cndmask_b32 v118, v110, v102, vcc
v_cndmask_b32 v119, v111, v103, vcc
v_lshlrev_b32 v9, 5, v1
s_lshl_b32 s6, s5, 11
s_add_u32 s6, s6, 122880
v_add_u32 v10, s6, v9
s_xor_b32 s6, s5, 1
s_lshl_b32 s6, s6, 11
s_add_u32 s6, s6, 122880
v_add_u32 v11, s6, v9
s_lshl_b32 s71, s65, 1
s_add_u32 s71, s71, s67
s_lshl_b32 s72, s71, 11
s_lshl_b32 s6, s66, 10
s_add_u32 s72, s72, s6
v_lshlrev_b32 v9, 2, v1
s_cmp_eq_u32 s66, 0
s_cbranch_scc1 LG_wm0a
ds_write_b128 v10, v[112:115]
ds_write_b32 v10, v120 offset:16
v_mov_b32 v112, v116
v_mov_b32 v113, v117
v_mov_b32 v114, v118
v_mov_b32 v115, v119
s_branch LG_wmj
LG_wm0a:
ds_write_b128 v10, v[116:119]
LG_wmj:
s_waitcnt vmcnt(0) lgkmcnt(0)
v_readfirstlane_b32 s6, v13
s_barrier
ds_read_b128 v[128:131], v11
ds_read_b32 v132, v11 offset:16
s_cmp_ge_u32 s6, 37
s_cbranch_scc1 LG_zok
LG_zpoll:
v_mov_b32 v8, 0
global_load_dword v8, v8, s[60:61] sc1
s_waitcnt vmcnt(0)
v_readfirstlane_b32 s6, v8
s_nop 1
s_cmp_ge_u32 s6, 37
s_cbranch_scc0 LG_zpoll
LG_zok:
s_waitcnt lgkmcnt(0)
v_add_f32 v112, v112, v128
v_add_f32 v113, v113, v129
v_add_f32 v114, v114, v130
v_add_f32 v115, v115, v131
v_add_f32 v120, v120, v132
buffer_atomic_add_f32 v112, v9, s[16:19], s72 offen offset:0
buffer_atomic_add_f32 v113, v9, s[16:19], s72 offen offset:256
buffer_atomic_add_f32 v114, v9, s[16:19], s72 offen offset:512
buffer_atomic_add_f32 v115, v9, s[16:19], s72 offen offset:768
s_cmp_eq_u32 s66, 0
s_cbranch_scc0 LG_wm1b
s_lshl_b32 s6, s71, 7
s_add_u32 s6, s6, 32768
s_mov_b64 exec, 0xffffffff
buffer_atomic_add_f32 v120, v9, s[16:19], s6 offen
s_mov_b64 exec, -1
LG_wm1b:
v_mfma_f32_32x32x16_bf16 v[32:47], v[232:235], v[168:171], v[32:47]
v_mfma_f32_32x32x16_bf16 v[48:63], v[232:235], v[172:175], v[48:63]
v_mfma_f32_32x32x16_bf16 v[32:47], v[236:239], v[176:179], v[32:47]
v_mfma_f32_32x32x16_bf16 v[48:63], v[236:239], v[180:183], v[48:63]
v_mfma_f32_32x32x16_bf16 v[32:47], v[240:243], v[184:187], v[32:47]
v_mfma_f32_32x32x16_bf16 v[48:63], v[240:243], v[188:191], v[48:63]
v_mfma_f32_32x32x16_bf16 v[32:47], v[244:247], v[192:195], v[32:47]
v_mfma_f32_32x32x16_bf16 v[48:63], v[244:247], v[196:199], v[48:63]
s_nop 10
v_pk_fma_f32 v[20:21], v[32:33], s[68:69], v[16:17]
v_pk_fma_f32 v[22:23], v[34:35], s[68:69], v[16:17]
v_pk_fma_f32 v[24:25], v[36:37], s[68:69], v[16:17]
v_pk_fma_f32 v[26:27], v[38:39], s[68:69], v[16:17]
v_exp_f32 v20, v20 clamp
v_exp_f32 v21, v21 clamp
v_exp_f32 v22, v22 clamp
v_exp_f32 v23, v23 clamp
v_exp_f32 v24, v24 clamp
v_exp_f32 v25, v25 clamp
v_exp_f32 v26, v26 clamp
v_exp_f32 v27, v27 clamp
v_max_f32 v32, s70, v32
v_max_f32 v33, s70, v33
v_max_f32 v34, s70, v34
v_max_f32 v35, s70, v35
v_max_f32 v36, s70, v36
v_max_f32 v37, s70, v37
v_max_f32 v38, s70, v38
v_max_f32 v39, s70, v39
v_pk_add_f32 v[32:33], v[32:33], v[20:21]
v_pk_add_f32 v[34:35], v[34:35], v[22:23]
v_pk_add_f32 v[36:37], v[36:37], v[24:25]
v_pk_add_f32 v[38:39], v[38:39], v[26:27]
v_pk_fma_f32 v[20:21], v[40:41], s[68:69], v[16:17]
v_pk_fma_f32 v[22:23], v[42:43], s[68:69], v[16:17]
v_pk_fma_f32 v[24:25], v[44:45], s[68:69], v[16:17]
v_pk_fma_f32 v[26:27], v[46:47], s[68:69], v[16:17]
v_exp_f32 v20, v20 clamp
v_exp_f32 v21, v21 clamp
v_exp_f32 v22, v22 clamp
v_exp_f32 v23, v23 clamp
v_exp_f32 v24, v24 clamp
v_exp_f32 v25, v25 clamp
v_exp_f32 v26, v26 clamp
v_exp_f32 v27, v27 clamp
v_max_f32 v40, s70, v40
v_max_f32 v41, s70, v41
v_max_f32 v42, s70, v42
v_max_f32 v43, s70, v43
v_max_f32 v44, s70, v44
v_max_f32 v45, s70, v45
v_max_f32 v46, s70, v46
v_max_f32 v47, s70, v47
v_pk_add_f32 v[40:41], v[40:41], v[20:21]
v_pk_add_f32 v[42:43], v[42:43], v[22:23]
v_pk_add_f32 v[44:45], v[44:45], v[24:25]
v_pk_add_f32 v[46:47], v[46:47], v[26:27]
v_pk_fma_f32 v[20:21], v[48:49], s[68:69], v[16:17]
v_pk_fma_f32 v[22:23], v[50:51], s[68:69], v[16:17]
v_pk_fma_f32 v[24:25], v[52:53], s[68:69], v[16:17]
v_pk_fma_f32 v[26:27], v[54:55], s[68:69], v[16:17]
v_exp_f32 v20, v20 clamp
v_exp_f32 v21, v21 clamp
v_exp_f32 v22, v22 clamp
v_exp_f32 v23, v23 clamp
v_exp_f32 v24, v24 clamp
v_exp_f32 v25, v25 clamp
v_exp_f32 v26, v26 clamp
v_exp_f32 v27, v27 clamp
v_max_f32 v48, s70, v48
v_max_f32 v49, s70, v49
v_max_f32 v50, s70, v50
v_max_f32 v51, s70, v51
v_max_f32 v52, s70, v52
v_max_f32 v53, s70, v53
v_max_f32 v54, s70, v54
v_max_f32 v55, s70, v55
v_pk_add_f32 v[48:49], v[48:49], v[20:21]
v_pk_add_f32 v[50:51], v[50:51], v[22:23]
v_pk_add_f32 v[52:53], v[52:53], v[24:25]
v_pk_add_f32 v[54:55], v[54:55], v[26:27]
v_pk_fma_f32 v[20:21], v[56:57], s[68:69], v[16:17]
v_pk_fma_f32 v[22:23], v[58:59], s[68:69], v[16:17]
v_pk_fma_f32 v[24:25], v[60:61], s[68:69], v[16:17]
v_pk_fma_f32 v[26:27], v[62:63], s[68:69], v[16:17]
v_exp_f32 v20, v20 clamp
v_exp_f32 v21, v21 clamp
v_exp_f32 v22, v22 clamp
v_exp_f32 v23, v23 clamp
v_exp_f32 v24, v24 clamp
v_exp_f32 v25, v25 clamp
v_exp_f32 v26, v26 clamp
v_exp_f32 v27, v27 clamp
v_max_f32 v56, s70, v56
v_max_f32 v57, s70, v57
v_max_f32 v58, s70, v58
v_max_f32 v59, s70, v59
v_max_f32 v60, s70, v60
v_max_f32 v61, s70, v61
v_max_f32 v62, s70, v62
v_max_f32 v63, s70, v63
v_pk_add_f32 v[56:57], v[56:57], v[20:21]
v_pk_add_f32 v[58:59], v[58:59], v[22:23]
v_pk_add_f32 v[60:61], v[60:61], v[24:25]
v_pk_add_f32 v[62:63], v[62:63], v[26:27]
v_cvt_pk_bf16_f32 v144, v32, v33
v_cvt_pk_bf16_f32 v145, v34, v35
v_cvt_pk_bf16_f32 v146, v36, v37
v_cvt_pk_bf16_f32 v147, v38, v39
v_cvt_pk_bf16_f32 v148, v40, v41
v_cvt_pk_bf16_f32 v149, v42, v43
v_cvt_pk_bf16_f32 v150, v44, v45
v_cvt_pk_bf16_f32 v151, v46, v47
v_cvt_pk_bf16_f32 v152, v48, v49
v_cvt_pk_bf16_f32 v153, v50, v51
v_cvt_pk_bf16_f32 v154, v52, v53
v_cvt_pk_bf16_f32 v155, v54, v55
v_cvt_pk_bf16_f32 v156, v56, v57
v_cvt_pk_bf16_f32 v157, v58, v59
v_cvt_pk_bf16_f32 v158, v60, v61
v_cvt_pk_bf16_f32 v159, v62, v63
s_lshl_b32 s71, s65, 1
s_add_u32 s71, s71, s67
s_lshl_b32 s6, s64, 2
s_lshl_b32 s7, s66, 1
s_add_u32 s6, s6, s7
s_lshl_b32 s6, s6, 15
s_lshl_b32 s7, s71, 11
s_add_u32 s6, s6, s7
s_add_u32 s6, s6, 65536
v_lshlrev_b32 v9, 4, v1
buffer_store_dwordx4 v[144:147], v9, s[16:19], s6 offen offset:0 sc1
buffer_store_dwordx4 v[148:151], v9, s[16:19], s6 offen offset:1024 sc1
s_add_u32 s6, s6, 32768
buffer_store_dwordx4 v[152:155], v9, s[16:19], s6 offen offset:0 sc1
buffer_store_dwordx4 v[156:159], v9, s[16:19], s6 offen offset:1024 sc1
s_waitcnt vmcnt(4)
v_mov_b32 v2, 162824
v_mov_b32 v3, 1
s_mov_b64 exec, 1
ds_add_rtn_u32 v3, v2, v3
s_waitcnt lgkmcnt(0)
v_readfirstlane_b32 s6, v3
s_nop 1
s_cmp_eq_u32 s6, 3
s_cbranch_scc0 LG_kvnl
s_lshl_b32 s6, s65, 11
s_add_u32 s6, s6, 4268032
s_mov_b64 exec, 0xffff
v_lshlrev_b32 v2, 7, v1
v_mov_b32 v3, 1
buffer_atomic_add v3, v2, s[16:19], s6 offen sc1
s_mov_b64 exec, -1
s_waitcnt vmcnt(1)
v_mov_b32 v2, 37
s_branch LK_fin_nw
LG_kvnl:
s_mov_b64 exec, -1
s_waitcnt vmcnt(0)
v_mov_b32 v2, 37
s_branch LK_fin_nw
LG_loader:
s_sub_u32 s66, s5, 4
v_lshrrev_b32 v8, 3, v1
v_and_b32 v9, 7, v1
v_lshrrev_b32 v10, 4, v1
v_xor_b32 v11, v9, v10
v_lshlrev_b32 v11, 4, v11
v_lshlrev_b32 v12, 10, v8
v_add_u32 v2, v11, v12
v_add_u32 v10, 4, v10
v_xor_b32 v11, v9, v10
v_lshlrev_b32 v11, 4, v11
v_add_u32 v3, v11, v12
v_bfe_u32 v10, v1, 4, 1
v_lshlrev_b32 v10, 2, v10
v_xor_b32 v11, v9, v10
v_lshlrev_b32 v11, 4, v11
v_mul_u32_u24 v12, 3072, v8
v_add_u32 v4, v11, v12
s_lshl_b32 s68, s64, 17
s_lshl_b32 s6, s66, 15
s_add_u32 s68, s68, s6
s_mul_i32 s69, s66, 49152
s_lshl_b32 s6, s65, 7
s_add_u32 s69, s69, s6
s_lshl_b32 s70, s66, 12
s_lshl_b32 s71, s66, 11
s_waitcnt lgkmcnt(0)
s_mov_b32 s8, s32
s_mov_b32 s9, s33
s_mov_b32 s12, s52
s_mov_b32 s13, s53
s_mov_b32 s16, s62
s_mov_b32 s17, s63
s_mov_b32 s20, s56
s_mov_b32 s21, s57
s_mov_b32 s24, s54
s_mov_b32 s25, s55
s_mov_b32 s28, s58
s_mov_b32 s29, s59
s_add_u32 s6, s68, 0
s_add_u32 m0, s70, 0
s_nop 0
buffer_load_dwordx4 v2, s[8:11], s6 offen lds
s_add_u32 s6, s68, 8192
s_add_u32 m0, s70, 1024
s_nop 0
buffer_load_dwordx4 v3, s[8:11], s6 offen lds
s_add_u32 s6, s68, 16384
s_add_u32 m0, s70, 2048
s_nop 0
buffer_load_dwordx4 v2, s[8:11], s6 offen lds
s_add_u32 s6, s68, 24576
s_add_u32 m0, s70, 3072
s_nop 0
buffer_load_dwordx4 v3, s[8:11], s6 offen lds
s_add_u32 s6, s69, 0
s_add_u32 m0, s71, 32768
s_nop 0
buffer_load_dwordx4 v4, s[12:15], s6 offen lds
s_add_u32 s6, s69, 24576
s_add_u32 m0, s71, 33792
s_nop 0
buffer_load_dwordx4 v4, s[12:15], s6 offen lds
s_add_u32 s6, s69, 1024
s_add_u32 m0, s71, 40960
s_nop 0
buffer_load_dwordx4 v4, s[12:15], s6 offen lds
s_add_u32 s6, s69, 25600
s_add_u32 m0, s71, 41984
s_nop 0
buffer_load_dwordx4 v4, s[12:15], s6 offen lds
s_add_u32 s6, s69, 2048
s_add_u32 m0, s71, 49152
s_nop 0
buffer_load_dwordx4 v4, s[12:15], s6 offen lds
s_add_u32 s6, s69, 26624
s_add_u32 m0, s71, 50176
s_nop 0
buffer_load_dwordx4 v4, s[12:15], s6 offen lds
s_cmp_lg_u32 s66, 0
s_cbranch_scc1 LG_nogate0
v_and_b32 v8, 3, v1
v_lshlrev_b32 v9, 5, v8
v_lshlrev_b32 v23, 4, v1
s_mov_b32 m0, 147456
v_add_u32 v20, 147456, v9
buffer_load_dwordx4 v23, s[20:23], 0 offen lds
v_lshrrev_b32 v10, 2, v1
s_lshl_b32 s6, s65, 4
v_add_u32 v10, s6, v10
v_lshrrev_b32 v11, 1, v10
v_and_b32 v11, 7, v11
v_lshlrev_b32 v12, 1, v8
v_xor_b32 v13, v12, v11
v_lshlrev_b32 v13, 4, v13
v_lshlrev_b32 v16, 7, v10
v_add_u32 v5, v13, v16
v_add_u32 v12, 1, v12
v_xor_b32 v13, v12, v11
v_lshlrev_b32 v13, 4, v13
v_add_u32 v6, v13, v16
v_mov_b32 v7, 0
v_add_u32 v21, 81920, v5
v_add_u32 v22, 81920, v6
LG_nogate0:
s_add_u32 s6, s68, 128
s_add_u32 m0, s70, 81920
s_nop 0
buffer_load_dwordx4 v2, s[8:11], s6 offen lds
s_add_u32 s6, s68, 8320
s_add_u32 m0, s70, 82944
s_nop 0
buffer_load_dwordx4 v3, s[8:11], s6 offen lds
s_add_u32 s6, s68, 16512
s_add_u32 m0, s70, 83968
s_nop 0
buffer_load_dwordx4 v2, s[8:11], s6 offen lds
s_add_u32 s6, s68, 24704
s_add_u32 m0, s70, 84992
s_nop 0
buffer_load_dwordx4 v3, s[8:11], s6 offen lds
s_waitcnt vmcnt(4)
s_barrier
s_add_u32 s6, s69, 196608
s_add_u32 m0, s71, 98304
s_nop 0
buffer_load_dwordx4 v4, s[12:15], s6 offen lds
s_add_u32 s6, s69, 221184
s_add_u32 m0, s71, 99328
s_nop 0
buffer_load_dwordx4 v4, s[12:15], s6 offen lds
s_add_u32 s6, s69, 197632
s_add_u32 m0, s71, 106496
s_nop 0
buffer_load_dwordx4 v4, s[12:15], s6 offen lds
s_add_u32 s6, s69, 222208
s_add_u32 m0, s71, 107520
s_nop 0
buffer_load_dwordx4 v4, s[12:15], s6 offen lds
s_add_u32 s6, s69, 198656
s_add_u32 m0, s71, 114688
s_nop 0
buffer_load_dwordx4 v4, s[12:15], s6 offen lds
s_add_u32 s6, s69, 223232
s_add_u32 m0, s71, 115712
s_nop 0
buffer_load_dwordx4 v4, s[12:15], s6 offen lds
s_add_u32 s6, s68, 256
s_add_u32 m0, s70, 16384
s_nop 0
buffer_load_dwordx4 v2, s[8:11], s6 offen lds
s_add_u32 s6, s68, 8448
s_add_u32 m0, s70, 17408
s_nop 0
buffer_load_dwordx4 v3, s[8:11], s6 offen lds
s_add_u32 s6, s68, 16640
s_add_u32 m0, s70, 18432
s_nop 0
buffer_load_dwordx4 v2, s[8:11], s6 offen lds
s_add_u32 s6, s68, 24832
s_add_u32 m0, s70, 19456
s_nop 0
buffer_load_dwordx4 v3, s[8:11], s6 offen lds
s_add_u32 s6, s69, 393216
s_add_u32 m0, s71, 57344
s_nop 0
buffer_load_dwordx4 v4, s[12:15], s6 offen lds
s_add_u32 s6, s69, 417792
s_add_u32 m0, s71, 58368
s_nop 0
buffer_load_dwordx4 v4, s[12:15], s6 offen lds
s_add_u32 s6, s69, 394240
s_add_u32 m0, s71, 65536
s_nop 0
buffer_load_dwordx4 v4, s[12:15], s6 offen lds
s_add_u32 s6, s69, 418816
s_add_u32 m0, s71, 66560
s_nop 0
buffer_load_dwordx4 v4, s[12:15], s6 offen lds
s_add_u32 s6, s69, 395264
s_add_u32 m0, s71, 73728
s_nop 0
buffer_load_dwordx4 v4, s[12:15], s6 offen lds
s_add_u32 s6, s69, 419840
s_add_u32 m0, s71, 74752
s_nop 0
buffer_load_dwordx4 v4, s[12:15], s6 offen lds
s_cmp_lg_u32 s66, 0
s_cbranch_scc1 LG_ng0
ds_read_b128 v[24:27], v5 offset:0
ds_read_b128 v[28:31], v6 offset:0
ds_read_b128 v[32:35], v20 offset:0
ds_read_b128 v[36:39], v20 offset:16
s_waitcnt lgkmcnt(0)
v_dot2c_f32_bf16 v7, v24, v32
v_dot2c_f32_bf16 v7, v25, v33
v_dot2c_f32_bf16 v7, v26, v34
v_dot2c_f32_bf16 v7, v27, v35
v_dot2c_f32_bf16 v7, v28, v36
v_dot2c_f32_bf16 v7, v29, v37
v_dot2c_f32_bf16 v7, v30, v38
v_dot2c_f32_bf16 v7, v31, v39
LG_ng0:
s_waitcnt vmcnt(10)
s_barrier
s_add_u32 s6, s68, 384
s_add_u32 m0, s70, 0
s_nop 0
buffer_load_dwordx4 v2, s[8:11], s6 offen lds
s_add_u32 s6, s68, 8576
s_add_u32 m0, s70, 1024
s_nop 0
buffer_load_dwordx4 v3, s[8:11], s6 offen lds
s_add_u32 s6, s68, 16768
s_add_u32 m0, s70, 2048
s_nop 0
buffer_load_dwordx4 v2, s[8:11], s6 offen lds
s_add_u32 s6, s68, 24960
s_add_u32 m0, s70, 3072
s_nop 0
buffer_load_dwordx4 v3, s[8:11], s6 offen lds
s_add_u32 s6, s69, 589824
s_add_u32 m0, s71, 32768
s_nop 0
buffer_load_dwordx4 v4, s[12:15], s6 offen lds
s_add_u32 s6, s69, 614400
s_add_u32 m0, s71, 33792
s_nop 0
buffer_load_dwordx4 v4, s[12:15], s6 offen lds
s_add_u32 s6, s69, 590848
s_add_u32 m0, s71, 40960
s_nop 0
buffer_load_dwordx4 v4, s[12:15], s6 offen lds
s_add_u32 s6, s69, 615424
s_add_u32 m0, s71, 41984
s_nop 0
buffer_load_dwordx4 v4, s[12:15], s6 offen lds
s_add_u32 s6, s69, 591872
s_add_u32 m0, s71, 49152
s_nop 0
buffer_load_dwordx4 v4, s[12:15], s6 offen lds
s_add_u32 s6, s69, 616448
s_add_u32 m0, s71, 50176
s_nop 0
buffer_load_dwordx4 v4, s[12:15], s6 offen lds
s_cmp_lg_u32 s66, 0
s_cbranch_scc1 LG_ng1
ds_read_b128 v[24:27], v21
ds_read_b128 v[28:31], v22
ds_read_b128 v[32:35], v20 offset:128
ds_read_b128 v[36:39], v20 offset:144
s_waitcnt lgkmcnt(0)
v_dot2c_f32_bf16 v7, v24, v32
v_dot2c_f32_bf16 v7, v25, v33
v_dot2c_f32_bf16 v7, v26, v34
v_dot2c_f32_bf16 v7, v27, v35
v_dot2c_f32_bf16 v7, v28, v36
v_dot2c_f32_bf16 v7, v29, v37
v_dot2c_f32_bf16 v7, v30, v38
v_dot2c_f32_bf16 v7, v31, v39
LG_ng1:
s_waitcnt vmcnt(10)
s_barrier
s_add_u32 s6, s68, 512
s_add_u32 m0, s70, 81920
s_nop 0
buffer_load_dwordx4 v2, s[8:11], s6 offen lds
s_add_u32 s6, s68, 8704
s_add_u32 m0, s70, 82944
s_nop 0
buffer_load_dwordx4 v3, s[8:11], s6 offen lds
s_add_u32 s6, s68, 16896
s_add_u32 m0, s70, 83968
s_nop 0
buffer_load_dwordx4 v2, s[8:11], s6 offen lds
s_add_u32 s6, s68, 25088
s_add_u32 m0, s70, 84992
s_nop 0
buffer_load_dwordx4 v3, s[8:11], s6 offen lds
s_add_u32 s6, s69, 786432
s_add_u32 m0, s71, 98304
s_nop 0
buffer_load_dwordx4 v4, s[12:15], s6 offen lds
s_add_u32 s6, s69, 811008
s_add_u32 m0, s71, 99328
s_nop 0
buffer_load_dwordx4 v4, s[12:15], s6 offen lds
s_add_u32 s6, s69, 787456
s_add_u32 m0, s71, 106496
s_nop 0
buffer_load_dwordx4 v4, s[12:15], s6 offen lds
s_add_u32 s6, s69, 812032
s_add_u32 m0, s71, 107520
s_nop 0
buffer_load_dwordx4 v4, s[12:15], s6 offen lds
s_add_u32 s6, s69, 788480
s_add_u32 m0, s71, 114688
s_nop 0
buffer_load_dwordx4 v4, s[12:15], s6 offen lds
s_add_u32 s6, s69, 813056
s_add_u32 m0, s71, 115712
s_nop 0
buffer_load_dwordx4 v4, s[12:15], s6 offen lds
s_cmp_lg_u32 s66, 0
s_cbranch_scc1 LG_ng2
ds_read_b128 v[24:27], v5 offset:16384
ds_read_b128 v[28:31], v6 offset:16384
ds_read_b128 v[32:35], v20 offset:256
ds_read_b128 v[36:39], v20 offset:272
s_waitcnt lgkmcnt(0)
v_dot2c_f32_bf16 v7, v24, v32
v_dot2c_f32_bf16 v7, v25, v33
v_dot2c_f32_bf16 v7, v26, v34
v_dot2c_f32_bf16 v7, v27, v35
v_dot2c_f32_bf16 v7, v28, v36
v_dot2c_f32_bf16 v7, v29, v37
v_dot2c_f32_bf16 v7, v30, v38
v_dot2c_f32_bf16 v7, v31, v39
LG_ng2:
s_waitcnt vmcnt(10)
s_barrier
s_add_u32 s6, s68, 640
s_add_u32 m0, s70, 16384
s_nop 0
buffer_load_dwordx4 v2, s[8:11], s6 offen lds
s_add_u32 s6, s68, 8832
s_add_u32 m0, s70, 17408
s_nop 0
buffer_load_dwordx4 v3, s[8:11], s6 offen lds
s_add_u32 s6, s68, 17024
s_add_u32 m0, s70, 18432
s_nop 0
buffer_load_dwordx4 v2, s[8:11], s6 offen lds
s_add_u32 s6, s68, 25216
s_add_u32 m0, s70, 19456
s_nop 0
buffer_load_dwordx4 v3, s[8:11], s6 offen lds
s_add_u32 s6, s69, 983040
s_add_u32 m0, s71, 57344
s_nop 0
buffer_load_dwordx4 v4, s[12:15], s6 offen lds
s_add_u32 s6, s69, 1007616
s_add_u32 m0, s71, 58368
s_nop 0
buffer_load_dwordx4 v4, s[12:15], s6 offen lds
s_add_u32 s6, s69, 984064
s_add_u32 m0, s71, 65536
s_nop 0
buffer_load_dwordx4 v4, s[12:15], s6 offen lds
s_add_u32 s6, s69, 1008640
s_add_u32 m0, s71, 66560
s_nop 0
buffer_load_dwordx4 v4, s[12:15], s6 offen lds
s_add_u32 s6, s69, 985088
s_add_u32 m0, s71, 73728
s_nop 0
buffer_load_dwordx4 v4, s[12:15], s6 offen lds
s_add_u32 s6, s69, 1009664
s_add_u32 m0, s71, 74752
s_nop 0
buffer_load_dwordx4 v4, s[12:15], s6 offen lds
s_lshl_b32 s6, s4, 14
s_lshl_b32 s7, s66, 12
s_add_u32 s6, s6, s7
v_lshlrev_b32 v254, 7, v1
s_mov_b64 exec, 0xffffffff
buffer_load_dword v255, v254, s[24:27], s6 offen
s_mov_b64 exec, -1
s_cmp_lg_u32 s66, 0
s_cbranch_scc1 LG_ng3
ds_read_b128 v[24:27], v5 offset:0
ds_read_b128 v[28:31], v6 offset:0
ds_read_b128 v[32:35], v20 offset:384
ds_read_b128 v[36:39], v20 offset:400
s_waitcnt lgkmcnt(0)
v_dot2c_f32_bf16 v7, v24, v32
v_dot2c_f32_bf16 v7, v25, v33
v_dot2c_f32_bf16 v7, v26, v34
v_dot2c_f32_bf16 v7, v27, v35
v_dot2c_f32_bf16 v7, v28, v36
v_dot2c_f32_bf16 v7, v29, v37
v_dot2c_f32_bf16 v7, v30, v38
v_dot2c_f32_bf16 v7, v31, v39
LG_ng3:
s_waitcnt vmcnt(11)
s_barrier
s_add_u32 s6, s68, 768
s_add_u32 m0, s70, 0
s_nop 0
buffer_load_dwordx4 v2, s[8:11], s6 offen lds
s_add_u32 s6, s68, 8960
s_add_u32 m0, s70, 1024
s_nop 0
buffer_load_dwordx4 v3, s[8:11], s6 offen lds
s_add_u32 s6, s68, 17152
s_add_u32 m0, s70, 2048
s_nop 0
buffer_load_dwordx4 v2, s[8:11], s6 offen lds
s_add_u32 s6, s68, 25344
s_add_u32 m0, s70, 3072
s_nop 0
buffer_load_dwordx4 v3, s[8:11], s6 offen lds
s_add_u32 s6, s69, 1179648
s_add_u32 m0, s71, 32768
s_nop 0
buffer_load_dwordx4 v4, s[12:15], s6 offen lds
s_add_u32 s6, s69, 1204224
s_add_u32 m0, s71, 33792
s_nop 0
buffer_load_dwordx4 v4, s[12:15], s6 offen lds
s_add_u32 s6, s69, 1180672
s_add_u32 m0, s71, 40960
s_nop 0
buffer_load_dwordx4 v4, s[12:15], s6 offen lds
s_add_u32 s6, s69, 1205248
s_add_u32 m0, s71, 41984
s_nop 0
buffer_load_dwordx4 v4, s[12:15], s6 offen lds
s_add_u32 s6, s69, 1181696
s_add_u32 m0, s71, 49152
s_nop 0
buffer_load_dwordx4 v4, s[12:15], s6 offen lds
s_add_u32 s6, s69, 1206272
s_add_u32 m0, s71, 50176
s_nop 0
buffer_load_dwordx4 v4, s[12:15], s6 offen lds
s_cmp_lg_u32 s66, 0
s_cbranch_scc1 LG_ng4
ds_read_b128 v[24:27], v21
ds_read_b128 v[28:31], v22
ds_read_b128 v[32:35], v20 offset:512
ds_read_b128 v[36:39], v20 offset:528
s_waitcnt lgkmcnt(0)
v_dot2c_f32_bf16 v7, v24, v32
v_dot2c_f32_bf16 v7, v25, v33
v_dot2c_f32_bf16 v7, v26, v34
v_dot2c_f32_bf16 v7, v27, v35
v_dot2c_f32_bf16 v7, v28, v36
v_dot2c_f32_bf16 v7, v29, v37
v_dot2c_f32_bf16 v7, v30, v38
v_dot2c_f32_bf16 v7, v31, v39
LG_ng4:
s_waitcnt vmcnt(11)
s_barrier
s_add_u32 s6, s68, 896
s_add_u32 m0, s70, 81920
s_nop 0
buffer_load_dwordx4 v2, s[8:11], s6 offen lds
s_add_u32 s6, s68, 9088
s_add_u32 m0, s70, 82944
s_nop 0
buffer_load_dwordx4 v3, s[8:11], s6 offen lds
s_add_u32 s6, s68, 17280
s_add_u32 m0, s70, 83968
s_nop 0
buffer_load_dwordx4 v2, s[8:11], s6 offen lds
s_add_u32 s6, s68, 25472
s_add_u32 m0, s70, 84992
s_nop 0
buffer_load_dwordx4 v3, s[8:11], s6 offen lds
s_add_u32 s6, s69, 1376256
s_add_u32 m0, s71, 98304
s_nop 0
buffer_load_dwordx4 v4, s[12:15], s6 offen lds
s_add_u32 s6, s69, 1400832
s_add_u32 m0, s71, 99328
s_nop 0
buffer_load_dwordx4 v4, s[12:15], s6 offen lds
s_add_u32 s6, s69, 1377280
s_add_u32 m0, s71, 106496
s_nop 0
buffer_load_dwordx4 v4, s[12:15], s6 offen lds
s_add_u32 s6, s69, 1401856
s_add_u32 m0, s71, 107520
s_nop 0
buffer_load_dwordx4 v4, s[12:15], s6 offen lds
s_add_u32 s6, s69, 1378304
s_add_u32 m0, s71, 114688
s_nop 0
buffer_load_dwordx4 v4, s[12:15], s6 offen lds
s_add_u32 s6, s69, 1402880
s_add_u32 m0, s71, 115712
s_nop 0
buffer_load_dwordx4 v4, s[12:15], s6 offen lds
s_cmp_lg_u32 s66, 0
s_cbranch_scc1 LG_ng5
ds_read_b128 v[24:27], v5 offset:16384
ds_read_b128 v[28:31], v6 offset:16384
ds_read_b128 v[32:35], v20 offset:640
ds_read_b128 v[36:39], v20 offset:656
s_waitcnt lgkmcnt(0)
v_dot2c_f32_bf16 v7, v24, v32
v_dot2c_f32_bf16 v7, v25, v33
v_dot2c_f32_bf16 v7, v26, v34
v_dot2c_f32_bf16 v7, v27, v35
v_dot2c_f32_bf16 v7, v28, v36
v_dot2c_f32_bf16 v7, v29, v37
v_dot2c_f32_bf16 v7, v30, v38
v_dot2c_f32_bf16 v7, v31, v39
LG_ng5:
s_waitcnt vmcnt(10)
s_barrier
s_cmp_lg_u32 s66, 0
s_cbranch_scc1 LG_ng6
ds_read_b128 v[24:27], v5 offset:0
ds_read_b128 v[28:31], v6 offset:0
ds_read_b128 v[32:35], v20 offset:768
ds_read_b128 v[36:39], v20 offset:784
s_waitcnt lgkmcnt(0)
v_dot2c_f32_bf16 v7, v24, v32
v_dot2c_f32_bf16 v7, v25, v33
v_dot2c_f32_bf16 v7, v26, v34
v_dot2c_f32_bf16 v7, v27, v35
v_dot2c_f32_bf16 v7, v28, v36
v_dot2c_f32_bf16 v7, v29, v37
v_dot2c_f32_bf16 v7, v30, v38
v_dot2c_f32_bf16 v7, v31, v39
LG_ng6:
s_waitcnt vmcnt(0)
s_barrier
s_cmp_lg_u32 s66, 0
s_cbranch_scc1 LG_ng7
ds_read_b128 v[24:27], v21
ds_read_b128 v[28:31], v22
ds_read_b128 v[32:35], v20 offset:896
ds_read_b128 v[36:39], v20 offset:912
s_waitcnt lgkmcnt(0)
v_dot2c_f32_bf16 v7, v24, v32
v_dot2c_f32_bf16 v7, v25, v33
v_dot2c_f32_bf16 v7, v26, v34
v_dot2c_f32_bf16 v7, v27, v35
v_dot2c_f32_bf16 v7, v28, v36
v_dot2c_f32_bf16 v7, v29, v37
v_dot2c_f32_bf16 v7, v30, v38
v_dot2c_f32_bf16 v7, v31, v39
LG_ng7:
v_lshrrev_b32 v18, 3, v1
v_lshlrev_b32 v18, 10, v18
v_and_b32 v19, 7, v1
v_bfe_u32 v17, v1, 4, 1
v_lshlrev_b32 v17, 2, v17
v_xor_b32 v19, v19, v17
v_lshlrev_b32 v19, 4, v19
v_add_u32 v18, v18, v19
s_and_b32 s7, s4, 7
s_lshl_b32 s7, s7, 7
s_lshl_b32 s6, s66, 13
s_add_u32 s7, s7, s6
s_lshl_b32 s79, s66, 10
s_add_u32 s6, s7, 0
s_add_u32 m0, s79, 0
s_nop 0
buffer_load_dwordx4 v18, s[24:27], s6 offen lds
s_add_u32 s6, s7, 32768
s_add_u32 m0, s79, 4096
s_nop 0
buffer_load_dwordx4 v18, s[24:27], s6 offen lds
s_add_u32 s6, s7, 65536
s_add_u32 m0, s79, 8192
s_nop 0
buffer_load_dwordx4 v18, s[24:27], s6 offen lds
s_add_u32 s6, s7, 98304
s_add_u32 m0, s79, 12288
s_nop 0
buffer_load_dwordx4 v18, s[24:27], s6 offen lds
s_add_u32 s6, s7, 131072
s_add_u32 m0, s79, 16384
s_nop 0
buffer_load_dwordx4 v18, s[24:27], s6 offen lds
s_add_u32 s6, s7, 163840
s_add_u32 m0, s79, 20480
s_nop 0
buffer_load_dwordx4 v18, s[24:27], s6 offen lds
s_add_u32 s6, s7, 196608
s_add_u32 m0, s79, 24576
s_nop 0
buffer_load_dwordx4 v18, s[24:27], s6 offen lds
s_add_u32 s6, s7, 229376
s_add_u32 m0, s79, 28672
s_nop 0
buffer_load_dwordx4 v18, s[24:27], s6 offen lds
s_add_u32 s6, s7, 262144
s_add_u32 m0, s79, 32768
s_nop 0
buffer_load_dwordx4 v18, s[24:27], s6 offen lds
s_add_u32 s6, s7, 294912
s_add_u32 m0, s79, 36864
s_nop 0
buffer_load_dwordx4 v18, s[24:27], s6 offen lds
s_add_u32 s6, s7, 327680
s_add_u32 m0, s79, 40960
s_nop 0
buffer_load_dwordx4 v18, s[24:27], s6 offen lds
s_add_u32 s6, s7, 360448
s_add_u32 m0, s79, 45056
s_nop 0
buffer_load_dwordx4 v18, s[24:27], s6 offen lds
s_add_u32 s6, s7, 393216
s_add_u32 m0, s79, 49152
s_nop 0
buffer_load_dwordx4 v18, s[24:27], s6 offen lds
s_add_u32 s6, s7, 425984
s_add_u32 m0, s79, 53248
s_nop 0
buffer_load_dwordx4 v18, s[24:27], s6 offen lds
s_add_u32 s6, s7, 458752
s_add_u32 m0, s79, 57344
s_nop 0
buffer_load_dwordx4 v18, s[24:27], s6 offen lds
s_add_u32 s6, s7, 491520
s_add_u32 m0, s79, 61440
s_nop 0
buffer_load_dwordx4 v18, s[24:27], s6 offen lds
s_barrier
s_cmp_lg_u32 s66, 0
s_cbranch_scc1 LG_gdone
v_add_f32_dpp v7, v7, v7 quad_perm:[1,0,3,2] row_mask:0xf bank_mask:0xf
s_nop 1
v_add_f32_dpp v7, v7, v7 quad_perm:[2,3,0,1] row_mask:0xf bank_mask:0xf
s_mov_b32 s6, 0xbfb8aa3b
v_mul_f32 v7, s6, v7
v_exp_f32 v7, v7
s_nop 0
v_add_f32 v7, 1.0, v7
v_rcp_f32 v7, v7
s_lshl_b32 s6, s64, 9
s_lshl_b32 s7, s65, 6
s_add_u32 s6, s6, s7
s_add_u32 s6, s6, 55296
v_and_b32 v8, 3, v1
v_cmp_eq_u32 vcc, 0, v8
v_and_b32 v9, 60, v1
s_nop 0
s_and_saveexec_b64 s[76:77], vcc
buffer_store_dword v7, v9, s[16:19], s6 offen sc1
s_mov_b64 exec, s[76:77]
LG_gdone:
s_branch LK_fin
LK_conv:
s_nop 4
s_lshl_b32 s64, s3, 4
s_add_u32 s64, s64, s4
s_sub_u32 s64, s64, 16
s_cmp_ge_u32 s5, 4
s_cbranch_scc1 LC_helper
s_lshl_b32 s65, s64, 2
s_add_u32 s65, s65, s5
s_lshl_b32 s6, s65, 8
v_lshlrev_b32 v2, 2, v1
v_add_u32 v2, s6, v2
s_waitcnt lgkmcnt(0)
s_mov_b32 s8, s32
s_mov_b32 s9, s33
s_mov_b32 s12, s52
s_mov_b32 s13, s53
s_mov_b32 s16, s62
s_mov_b32 s17, s63
s_mov_b32 s20, s56
s_mov_b32 s21, s57
s_mov_b32 s24, s54
s_mov_b32 s25, s55
s_mov_b32 s28, s58
s_mov_b32 s29, s59
global_load_dword v4, v2, s[34:35]
global_load_dword v5, v2, s[36:37]
global_load_dword v6, v2, s[38:39]
global_load_dword v7, v2, s[40:41]
global_load_dword v8, v2, s[42:43]
global_load_dword v9, v2, s[44:45]
s_lshr_b32 s6, s65, 1
s_lshl_b32 s6, s6, 2
s_add_u32 s66, s46, s6
s_addc_u32 s67, s47, 0
s_add_u32 s68, s48, s6
s_addc_u32 s69, s49, 0
s_load_dword s70, s[66:67], 0
s_load_dword s71, s[68:69], 0
s_mul_i32 s72, s5, 17408
v_lshlrev_b32 v12, 3, v1
v_add_u32 v12, s72, v12
v_and_b32 v14, 15, v1
v_lshrrev_b32 v15, 4, v1
v_mul_u32_u24 v13, 544, v14
v_lshlrev_b32 v16, 4, v15
v_add_u32 v13, v13, v16
v_add_u32 v13, s72, v13
s_mul_i32 s73, s5, 4608
s_add_u32 s73, s73, 69632
s_add_u32 s74, s73, 480
s_mul_i32 s75, s5, 2048
s_add_u32 s75, s75, 88064
v_mov_b32 v20, 0
v_mov_b32 v21, 0
v_mov_b32 v22, 0
v_mov_b32 v23, 0
v_lshlrev_b32 v16, 4, v1
v_add_u32 v16, s73, v16
s_mov_b32 exec_lo, 0x3fffffff
s_mov_b32 exec_hi, 0
ds_write_b128 v16, v[20:23]
s_mov_b64 exec, -1
v_lshrrev_b32 v16, 1, v15
v_lshlrev_b32 v16, 8, v16
v_and_b32 v18, 1, v15
v_lshlrev_b32 v18, 3, v18
v_add_u32 v16, v16, v18
v_lshlrev_b32 v18, 4, v14
v_add_u32 v16, v16, v18
v_add_u32 v240, s74, v16
v_lshlrev_b32 v16, 6, v15
v_lshlrev_b32 v18, 2, v14
v_add_u32 v16, v16, v18
v_add_u32 v18, 2, v16
v_lshlrev_b32 v19, 6, v15
v_lshlrev_b32 v20, 1, v14
v_add_u32 v19, v19, v20
v_add_u32 v20, 32, v19
v_cmp_gt_u32 vcc, 2, v15
s_nop 1
v_cndmask_b32 v16, v19, v16, vcc
v_cndmask_b32 v18, v20, v18, vcc
v_lshlrev_b32 v16, 2, v16
v_lshlrev_b32 v18, 2, v18
v_add_u32 v241, s75, v16
v_add_u32 v242, s75, v18
v_lshlrev_b32 v16, 6, v15
v_add_u32 v16, v16, v14
v_lshlrev_b32 v16, 2, v16
v_add_u32 v243, s75, v16
v_lshlrev_b32 v16, 4, v1
v_add_u32 v244, s75, v16
v_add_u32 v247, s74, v16
v_lshlrev_b32 v16, 3, v1
v_add_u32 v245, s75, v16
v_lshlrev_b32 v16, 2, v1
v_add_u32 v246, s75, v16
s_mul_i32 s6, s5, 16640
s_add_u32 s6, s6, 96280
v_and_b32 v16, 3, v14
v_sub_u32 v16, 3, v16
v_mul_u32_u24 v16, 4160, v16
v_lshlrev_b32 v18, 4, v15
v_add_u32 v16, v16, v18
v_lshrrev_b32 v18, 2, v14
v_lshlrev_b32 v18, 3, v18
v_sub_u32 v16, v16, v18
v_add_u32 v248, s6, v16
v_lshlrev_b32 v16, 5, v14
v_lshlrev_b32 v18, 4, v15
v_add_u32 v16, v16, v18
v_add_u32 v249, s73, v16
s_waitcnt lgkmcnt(0)
s_and_b32 s6, s65, 1
s_lshl_b32 s6, s6, 4
s_lshr_b32 s70, s70, s6
s_lshl_b32 s70, s70, 16
s_lshr_b32 s71, s71, s6
s_lshl_b32 s71, s71, 16
s_mov_b32 s76, 1069066811
s_mov_b32 s77, 0x32a57060
v_mov_b32 v16, s70
v_mul_f32 v17, s76, v16
v_fma_f32 v18, v16, s76, -v17
v_fma_f32 v18, v16, s77, v18
v_exp_f32 v17, v17
v_mul_f32 v18, 0x3f317218, v18
v_fma_f32 v17, v17, v18, v17
v_cvt_pk_bf16_f32 v17, v17, v17
v_and_b32 v17, 0xffff0000, v17
v_cmp_eq_u32 vcc, 0, v1
v_mov_b32 v19, s71
s_nop 0
v_cndmask_b32 v19, 0, v19, vcc
s_waitcnt vmcnt(0)
v_lshlrev_b32 v70, 16, v4
v_lshlrev_b32 v71, 16, v5
v_lshlrev_b32 v72, 16, v6
v_lshlrev_b32 v73, 16, v7
v_lshlrev_b32 v74, 16, v8
v_lshlrev_b32 v75, 16, v9
v_and_b32 v118, 0xffff0000, v4
v_and_b32 v119, 0xffff0000, v5
v_and_b32 v120, 0xffff0000, v6
v_and_b32 v121, 0xffff0000, v7
v_and_b32 v122, 0xffff0000, v8
v_and_b32 v123, 0xffff0000, v9
v_mul_f32 v70, v17, v70
v_mul_f32 v71, v17, v71
v_mul_f32 v72, v17, v72
v_mul_f32 v73, v17, v73
v_mul_f32 v32, s76, v70
v_mul_f32 v33, 1042479491, v71
v_mul_f32 v118, v17, v118
v_mul_f32 v119, v17, v119
v_mul_f32 v120, v17, v120
v_mul_f32 v121, v17, v121
v_mul_f32 v80, s76, v118
v_mul_f32 v81, 1042479491, v119
v_pk_mul_f32 v[42:43], v[74:75], v[72:73] op_sel:[0,0] op_sel_hi:[0,1]
v_pk_mul_f32 v[90:91], v[122:123], v[120:121] op_sel:[0,0] op_sel_hi:[0,1]
v_pk_fma_f32 v[34:35], v[74:75], v[72:73], v[42:43] op_sel:[1,1,0] op_sel_hi:[1,0,1] neg_lo:[1,0,0]
v_pk_fma_f32 v[82:83], v[122:123], v[120:121], v[90:91] op_sel:[1,1,0] op_sel_hi:[1,0,1] neg_lo:[1,0,0]
v_mul_f32 v70, 0x41000000, v32
v_mul_f32 v71, 0x41000000, v33
v_fract_f32 v71, v71
v_mul_f32 v118, 0x41000000, v80
v_mul_f32 v119, 0x41000000, v81
v_fract_f32 v119, v119
v_exp_f32 v70, v70
v_cos_f32 v72, v71
v_sin_f32 v73, v71
v_exp_f32 v118, v118
v_cos_f32 v120, v119
v_sin_f32 v121, v119
v_mul_f32 v38, v70, v72
v_mul_f32 v39, v70, v73
v_mul_f32 v86, v118, v120
v_mul_f32 v87, v118, v121
v_mul_f32 v70, 0x43000000, v32
v_mul_f32 v71, 0x43000000, v33
v_fract_f32 v71, v71
v_mul_f32 v118, 0x43000000, v80
v_mul_f32 v119, 0x43000000, v81
v_fract_f32 v119, v119
v_exp_f32 v70, v70
v_cos_f32 v72, v71
v_sin_f32 v73, v71
v_exp_f32 v118, v118
v_cos_f32 v120, v119
v_sin_f32 v121, v119
v_mul_f32 v40, v70, v72
v_mul_f32 v41, v70, v73
v_mul_f32 v88, v118, v120
v_mul_f32 v89, v118, v121
v_mov_b32 v70, v32
v_fract_f32 v71, v33
v_mov_b32 v118, v80
v_fract_f32 v119, v81
v_exp_f32 v70, v70
v_cos_f32 v72, v71
v_sin_f32 v73, v71
v_exp_f32 v118, v118
v_cos_f32 v120, v119
v_sin_f32 v121, v119
v_mul_f32 v36, v70, v72
v_mul_f32 v37, v70, v73
v_mul_f32 v84, v118, v120
v_mul_f32 v85, v118, v121
v_cvt_pk_bf16_f32 v24, v34, -v35
v_cvt_pk_bf16_f32 v25, v82, -v83
ds_write_b64 v12, v[24:25] offset:0
v_pk_mul_f32 v[42:43], v[34:35], v[38:39] op_sel:[0,0] op_sel_hi:[0,1]
v_pk_mul_f32 v[90:91], v[82:83], v[86:87] op_sel:[0,0] op_sel_hi:[0,1]
v_pk_fma_f32 v[70:71], v[34:35], v[38:39], v[42:43] op_sel:[1,1,0] op_sel_hi:[1,0,1] neg_lo:[1,0,0]
v_pk_fma_f32 v[118:119], v[82:83], v[86:87], v[90:91] op_sel:[1,1,0] op_sel_hi:[1,0,1] neg_lo:[1,0,0]
v_cvt_pk_bf16_f32 v26, v70, -v71
v_cvt_pk_bf16_f32 v27, v118, -v119
ds_write_b64 v12, v[26:27] offset:544
v_pk_mul_f32 v[42:43], v[70:71], v[38:39] op_sel:[0,0] op_sel_hi:[0,1]
v_pk_mul_f32 v[90:91], v[118:119], v[86:87] op_sel:[0,0] op_sel_hi:[0,1]
v_pk_fma_f32 v[72:73], v[70:71], v[38:39], v[42:43] op_sel:[1,1,0] op_sel_hi:[1,0,1] neg_lo:[1,0,0]
v_pk_fma_f32 v[120:121], v[118:119], v[86:87], v[90:91] op_sel:[1,1,0] op_sel_hi:[1,0,1] neg_lo:[1,0,0]
v_cvt_pk_bf16_f32 v28, v72, -v73
v_cvt_pk_bf16_f32 v29, v120, -v121
ds_write_b64 v12, v[28:29] offset:1088
v_pk_mul_f32 v[42:43], v[72:73], v[38:39] op_sel:[0,0] op_sel_hi:[0,1]
v_pk_mul_f32 v[90:91], v[120:121], v[86:87] op_sel:[0,0] op_sel_hi:[0,1]
v_pk_fma_f32 v[70:71], v[72:73], v[38:39], v[42:43] op_sel:[1,1,0] op_sel_hi:[1,0,1] neg_lo:[1,0,0]
v_pk_fma_f32 v[118:119], v[120:121], v[86:87], v[90:91] op_sel:[1,1,0] op_sel_hi:[1,0,1] neg_lo:[1,0,0]
v_cvt_pk_bf16_f32 v30, v70, -v71
v_cvt_pk_bf16_f32 v31, v118, -v119
ds_write_b64 v12, v[30:31] offset:1632
v_pk_mul_f32 v[42:43], v[70:71], v[38:39] op_sel:[0,0] op_sel_hi:[0,1]
v_pk_mul_f32 v[90:91], v[118:119], v[86:87] op_sel:[0,0] op_sel_hi:[0,1]
v_pk_fma_f32 v[72:73], v[70:71], v[38:39], v[42:43] op_sel:[1,1,0] op_sel_hi:[1,0,1] neg_lo:[1,0,0]
v_pk_fma_f32 v[120:121], v[118:119], v[86:87], v[90:91] op_sel:[1,1,0] op_sel_hi:[1,0,1] neg_lo:[1,0,0]
v_cvt_pk_bf16_f32 v24, v72, -v73
v_cvt_pk_bf16_f32 v25, v120, -v121
ds_write_b64 v12, v[24:25] offset:2176
v_pk_mul_f32 v[42:43], v[72:73], v[38:39] op_sel:[0,0] op_sel_hi:[0,1]
v_pk_mul_f32 v[90:91], v[120:121], v[86:87] op_sel:[0,0] op_sel_hi:[0,1]
v_pk_fma_f32 v[70:71], v[72:73], v[38:39], v[42:43] op_sel:[1,1,0] op_sel_hi:[1,0,1] neg_lo:[1,0,0]
v_pk_fma_f32 v[118:119], v[120:121], v[86:87], v[90:91] op_sel:[1,1,0] op_sel_hi:[1,0,1] neg_lo:[1,0,0]
v_cvt_pk_bf16_f32 v26, v70, -v71
v_cvt_pk_bf16_f32 v27, v118, -v119
ds_write_b64 v12, v[26:27] offset:2720
v_pk_mul_f32 v[42:43], v[70:71], v[38:39] op_sel:[0,0] op_sel_hi:[0,1]
v_pk_mul_f32 v[90:91], v[118:119], v[86:87] op_sel:[0,0] op_sel_hi:[0,1]
v_pk_fma_f32 v[72:73], v[70:71], v[38:39], v[42:43] op_sel:[1,1,0] op_sel_hi:[1,0,1] neg_lo:[1,0,0]
v_pk_fma_f32 v[120:121], v[118:119], v[86:87], v[90:91] op_sel:[1,1,0] op_sel_hi:[1,0,1] neg_lo:[1,0,0]
v_cvt_pk_bf16_f32 v28, v72, -v73
v_cvt_pk_bf16_f32 v29, v120, -v121
ds_write_b64 v12, v[28:29] offset:3264
v_pk_mul_f32 v[42:43], v[72:73], v[38:39] op_sel:[0,0] op_sel_hi:[0,1]
v_pk_mul_f32 v[90:91], v[120:121], v[86:87] op_sel:[0,0] op_sel_hi:[0,1]
v_pk_fma_f32 v[70:71], v[72:73], v[38:39], v[42:43] op_sel:[1,1,0] op_sel_hi:[1,0,1] neg_lo:[1,0,0]
v_pk_fma_f32 v[118:119], v[120:121], v[86:87], v[90:91] op_sel:[1,1,0] op_sel_hi:[1,0,1] neg_lo:[1,0,0]
v_cvt_pk_bf16_f32 v30, v70, -v71
v_cvt_pk_bf16_f32 v31, v118, -v119
ds_write_b64 v12, v[30:31] offset:3808
v_pk_mul_f32 v[42:43], v[70:71], v[38:39] op_sel:[0,0] op_sel_hi:[0,1]
v_pk_mul_f32 v[90:91], v[118:119], v[86:87] op_sel:[0,0] op_sel_hi:[0,1]
v_pk_fma_f32 v[72:73], v[70:71], v[38:39], v[42:43] op_sel:[1,1,0] op_sel_hi:[1,0,1] neg_lo:[1,0,0]
v_pk_fma_f32 v[120:121], v[118:119], v[86:87], v[90:91] op_sel:[1,1,0] op_sel_hi:[1,0,1] neg_lo:[1,0,0]
v_cvt_pk_bf16_f32 v24, v72, -v73
v_cvt_pk_bf16_f32 v25, v120, -v121
ds_write_b64 v12, v[24:25] offset:4352
v_pk_mul_f32 v[42:43], v[72:73], v[38:39] op_sel:[0,0] op_sel_hi:[0,1]
v_pk_mul_f32 v[90:91], v[120:121], v[86:87] op_sel:[0,0] op_sel_hi:[0,1]
v_pk_fma_f32 v[70:71], v[72:73], v[38:39], v[42:43] op_sel:[1,1,0] op_sel_hi:[1,0,1] neg_lo:[1,0,0]
v_pk_fma_f32 v[118:119], v[120:121], v[86:87], v[90:91] op_sel:[1,1,0] op_sel_hi:[1,0,1] neg_lo:[1,0,0]
v_cvt_pk_bf16_f32 v26, v70, -v71
v_cvt_pk_bf16_f32 v27, v118, -v119
ds_write_b64 v12, v[26:27] offset:4896
v_pk_mul_f32 v[42:43], v[70:71], v[38:39] op_sel:[0,0] op_sel_hi:[0,1]
v_pk_mul_f32 v[90:91], v[118:119], v[86:87] op_sel:[0,0] op_sel_hi:[0,1]
v_pk_fma_f32 v[72:73], v[70:71], v[38:39], v[42:43] op_sel:[1,1,0] op_sel_hi:[1,0,1] neg_lo:[1,0,0]
v_pk_fma_f32 v[120:121], v[118:119], v[86:87], v[90:91] op_sel:[1,1,0] op_sel_hi:[1,0,1] neg_lo:[1,0,0]
v_cvt_pk_bf16_f32 v28, v72, -v73
v_cvt_pk_bf16_f32 v29, v120, -v121
ds_write_b64 v12, v[28:29] offset:5440
v_pk_mul_f32 v[42:43], v[72:73], v[38:39] op_sel:[0,0] op_sel_hi:[0,1]
v_pk_mul_f32 v[90:91], v[120:121], v[86:87] op_sel:[0,0] op_sel_hi:[0,1]
v_pk_fma_f32 v[70:71], v[72:73], v[38:39], v[42:43] op_sel:[1,1,0] op_sel_hi:[1,0,1] neg_lo:[1,0,0]
v_pk_fma_f32 v[118:119], v[120:121], v[86:87], v[90:91] op_sel:[1,1,0] op_sel_hi:[1,0,1] neg_lo:[1,0,0]
v_cvt_pk_bf16_f32 v30, v70, -v71
v_cvt_pk_bf16_f32 v31, v118, -v119
ds_write_b64 v12, v[30:31] offset:5984
v_pk_mul_f32 v[42:43], v[70:71], v[38:39] op_sel:[0,0] op_sel_hi:[0,1]
v_pk_mul_f32 v[90:91], v[118:119], v[86:87] op_sel:[0,0] op_sel_hi:[0,1]
v_pk_fma_f32 v[72:73], v[70:71], v[38:39], v[42:43] op_sel:[1,1,0] op_sel_hi:[1,0,1] neg_lo:[1,0,0]
v_pk_fma_f32 v[120:121], v[118:119], v[86:87], v[90:91] op_sel:[1,1,0] op_sel_hi:[1,0,1] neg_lo:[1,0,0]
v_cvt_pk_bf16_f32 v24, v72, -v73
v_cvt_pk_bf16_f32 v25, v120, -v121
ds_write_b64 v12, v[24:25] offset:6528
v_pk_mul_f32 v[42:43], v[72:73], v[38:39] op_sel:[0,0] op_sel_hi:[0,1]
v_pk_mul_f32 v[90:91], v[120:121], v[86:87] op_sel:[0,0] op_sel_hi:[0,1]
v_pk_fma_f32 v[70:71], v[72:73], v[38:39], v[42:43] op_sel:[1,1,0] op_sel_hi:[1,0,1] neg_lo:[1,0,0]
v_pk_fma_f32 v[118:119], v[120:121], v[86:87], v[90:91] op_sel:[1,1,0] op_sel_hi:[1,0,1] neg_lo:[1,0,0]
v_cvt_pk_bf16_f32 v26, v70, -v71
v_cvt_pk_bf16_f32 v27, v118, -v119
ds_write_b64 v12, v[26:27] offset:7072
v_pk_mul_f32 v[42:43], v[70:71], v[38:39] op_sel:[0,0] op_sel_hi:[0,1]
v_pk_mul_f32 v[90:91], v[118:119], v[86:87] op_sel:[0,0] op_sel_hi:[0,1]
v_pk_fma_f32 v[72:73], v[70:71], v[38:39], v[42:43] op_sel:[1,1,0] op_sel_hi:[1,0,1] neg_lo:[1,0,0]
v_pk_fma_f32 v[120:121], v[118:119], v[86:87], v[90:91] op_sel:[1,1,0] op_sel_hi:[1,0,1] neg_lo:[1,0,0]
v_cvt_pk_bf16_f32 v28, v72, -v73
v_cvt_pk_bf16_f32 v29, v120, -v121
ds_write_b64 v12, v[28:29] offset:7616
v_pk_mul_f32 v[42:43], v[72:73], v[38:39] op_sel:[0,0] op_sel_hi:[0,1]
v_pk_mul_f32 v[90:91], v[120:121], v[86:87] op_sel:[0,0] op_sel_hi:[0,1]
v_pk_fma_f32 v[70:71], v[72:73], v[38:39], v[42:43] op_sel:[1,1,0] op_sel_hi:[1,0,1] neg_lo:[1,0,0]
v_pk_fma_f32 v[118:119], v[120:121], v[86:87], v[90:91] op_sel:[1,1,0] op_sel_hi:[1,0,1] neg_lo:[1,0,0]
v_cvt_pk_bf16_f32 v30, v70, -v71
v_cvt_pk_bf16_f32 v31, v118, -v119
ds_write_b64 v12, v[30:31] offset:8160
ds_read_b128 v[128:131], v13 offset:0
ds_read_b128 v[132:135], v13 offset:64
ds_read_b128 v[136:139], v13 offset:128
ds_read_b128 v[140:143], v13 offset:192
ds_read_b128 v[144:147], v13 offset:256
ds_read_b128 v[148:151], v13 offset:320
ds_read_b128 v[152:155], v13 offset:384
ds_read_b128 v[156:159], v13 offset:448
v_pk_mul_f32 v[42:43], v[40:41], v[40:41] op_sel:[0,0] op_sel_hi:[0,1]
v_pk_mul_f32 v[90:91], v[88:89], v[88:89] op_sel:[0,0] op_sel_hi:[0,1]
v_pk_fma_f32 v[58:59], v[40:41], v[40:41], v[42:43] op_sel:[1,1,0] op_sel_hi:[1,0,1] neg_lo:[1,0,0]
v_pk_fma_f32 v[106:107], v[88:89], v[88:89], v[90:91] op_sel:[1,1,0] op_sel_hi:[1,0,1] neg_lo:[1,0,0]
v_pk_mul_f32 v[42:43], v[58:59], v[40:41] op_sel:[0,0] op_sel_hi:[0,1]
v_pk_mul_f32 v[90:91], v[106:107], v[88:89] op_sel:[0,0] op_sel_hi:[0,1]
v_pk_fma_f32 v[60:61], v[58:59], v[40:41], v[42:43] op_sel:[1,1,0] op_sel_hi:[1,0,1] neg_lo:[1,0,0]
v_pk_fma_f32 v[108:109], v[106:107], v[88:89], v[90:91] op_sel:[1,1,0] op_sel_hi:[1,0,1] neg_lo:[1,0,0]
v_pk_mul_f32 v[42:43], v[60:61], v[40:41] op_sel:[0,0] op_sel_hi:[0,1]
v_pk_mul_f32 v[90:91], v[108:109], v[88:89] op_sel:[0,0] op_sel_hi:[0,1]
v_pk_fma_f32 v[62:63], v[60:61], v[40:41], v[42:43] op_sel:[1,1,0] op_sel_hi:[1,0,1] neg_lo:[1,0,0]
v_pk_fma_f32 v[110:111], v[108:109], v[88:89], v[90:91] op_sel:[1,1,0] op_sel_hi:[1,0,1] neg_lo:[1,0,0]
v_pk_mul_f32 v[42:43], v[62:63], v[40:41] op_sel:[0,0] op_sel_hi:[0,1]
v_pk_mul_f32 v[90:91], v[110:111], v[88:89] op_sel:[0,0] op_sel_hi:[0,1]
v_pk_fma_f32 v[64:65], v[62:63], v[40:41], v[42:43] op_sel:[1,1,0] op_sel_hi:[1,0,1] neg_lo:[1,0,0]
v_pk_fma_f32 v[112:113], v[110:111], v[88:89], v[90:91] op_sel:[1,1,0] op_sel_hi:[1,0,1] neg_lo:[1,0,0]
v_pk_mul_f32 v[42:43], v[64:65], v[40:41] op_sel:[0,0] op_sel_hi:[0,1]
v_pk_mul_f32 v[90:91], v[112:113], v[88:89] op_sel:[0,0] op_sel_hi:[0,1]
v_pk_fma_f32 v[66:67], v[64:65], v[40:41], v[42:43] op_sel:[1,1,0] op_sel_hi:[1,0,1] neg_lo:[1,0,0]
v_pk_fma_f32 v[114:115], v[112:113], v[88:89], v[90:91] op_sel:[1,1,0] op_sel_hi:[1,0,1] neg_lo:[1,0,0]
v_pk_mul_f32 v[42:43], v[66:67], v[40:41] op_sel:[0,0] op_sel_hi:[0,1]
v_pk_mul_f32 v[90:91], v[114:115], v[88:89] op_sel:[0,0] op_sel_hi:[0,1]
v_pk_fma_f32 v[68:69], v[66:67], v[40:41], v[42:43] op_sel:[1,1,0] op_sel_hi:[1,0,1] neg_lo:[1,0,0]
v_pk_fma_f32 v[116:117], v[114:115], v[88:89], v[90:91] op_sel:[1,1,0] op_sel_hi:[1,0,1] neg_lo:[1,0,0]
v_pk_mul_f32 v[42:43], v[68:69], v[40:41] op_sel:[0,0] op_sel_hi:[0,1]
v_pk_mul_f32 v[90:91], v[116:117], v[88:89] op_sel:[0,0] op_sel_hi:[0,1]
v_pk_fma_f32 v[74:75], v[68:69], v[40:41], v[42:43] op_sel:[1,1,0] op_sel_hi:[1,0,1] neg_lo:[1,0,0]
v_pk_fma_f32 v[122:123], v[116:117], v[88:89], v[90:91] op_sel:[1,1,0] op_sel_hi:[1,0,1] neg_lo:[1,0,0]
v_cvt_pk_bf16_f32 v24, v74, v75
v_cvt_pk_bf16_f32 v25, v122, v123
ds_write_b64 v12, v[24:25] offset:8704
v_pk_mul_f32 v[42:43], v[74:75], v[40:41] op_sel:[0,0] op_sel_hi:[0,1]
v_pk_mul_f32 v[90:91], v[122:123], v[88:89] op_sel:[0,0] op_sel_hi:[0,1]
v_pk_fma_f32 v[76:77], v[74:75], v[40:41], v[42:43] op_sel:[1,1,0] op_sel_hi:[1,0,1] neg_lo:[1,0,0]
v_pk_fma_f32 v[124:125], v[122:123], v[88:89], v[90:91] op_sel:[1,1,0] op_sel_hi:[1,0,1] neg_lo:[1,0,0]
v_cvt_pk_bf16_f32 v26, v76, v77
v_cvt_pk_bf16_f32 v27, v124, v125
ds_write_b64 v12, v[26:27] offset:9248
v_pk_mul_f32 v[42:43], v[76:77], v[40:41] op_sel:[0,0] op_sel_hi:[0,1]
v_pk_mul_f32 v[90:91], v[124:125], v[88:89] op_sel:[0,0] op_sel_hi:[0,1]
v_pk_fma_f32 v[74:75], v[76:77], v[40:41], v[42:43] op_sel:[1,1,0] op_sel_hi:[1,0,1] neg_lo:[1,0,0]
v_pk_fma_f32 v[122:123], v[124:125], v[88:89], v[90:91] op_sel:[1,1,0] op_sel_hi:[1,0,1] neg_lo:[1,0,0]
v_cvt_pk_bf16_f32 v28, v74, v75
v_cvt_pk_bf16_f32 v29, v122, v123
ds_write_b64 v12, v[28:29] offset:9792
v_pk_mul_f32 v[42:43], v[74:75], v[40:41] op_sel:[0,0] op_sel_hi:[0,1]
v_pk_mul_f32 v[90:91], v[122:123], v[88:89] op_sel:[0,0] op_sel_hi:[0,1]
v_pk_fma_f32 v[76:77], v[74:75], v[40:41], v[42:43] op_sel:[1,1,0] op_sel_hi:[1,0,1] neg_lo:[1,0,0]
v_pk_fma_f32 v[124:125], v[122:123], v[88:89], v[90:91] op_sel:[1,1,0] op_sel_hi:[1,0,1] neg_lo:[1,0,0]
v_cvt_pk_bf16_f32 v30, v76, v77
v_cvt_pk_bf16_f32 v31, v124, v125
ds_write_b64 v12, v[30:31] offset:10336
v_pk_mul_f32 v[42:43], v[76:77], v[40:41] op_sel:[0,0] op_sel_hi:[0,1]
v_pk_mul_f32 v[90:91], v[124:125], v[88:89] op_sel:[0,0] op_sel_hi:[0,1]
v_pk_fma_f32 v[74:75], v[76:77], v[40:41], v[42:43] op_sel:[1,1,0] op_sel_hi:[1,0,1] neg_lo:[1,0,0]
v_pk_fma_f32 v[122:123], v[124:125], v[88:89], v[90:91] op_sel:[1,1,0] op_sel_hi:[1,0,1] neg_lo:[1,0,0]
v_cvt_pk_bf16_f32 v24, v74, v75
v_cvt_pk_bf16_f32 v25, v122, v123
ds_write_b64 v12, v[24:25] offset:10880
v_pk_mul_f32 v[42:43], v[74:75], v[40:41] op_sel:[0,0] op_sel_hi:[0,1]
v_pk_mul_f32 v[90:91], v[122:123], v[88:89] op_sel:[0,0] op_sel_hi:[0,1]
v_pk_fma_f32 v[76:77], v[74:75], v[40:41], v[42:43] op_sel:[1,1,0] op_sel_hi:[1,0,1] neg_lo:[1,0,0]
v_pk_fma_f32 v[124:125], v[122:123], v[88:89], v[90:91] op_sel:[1,1,0] op_sel_hi:[1,0,1] neg_lo:[1,0,0]
v_cvt_pk_bf16_f32 v26, v76, v77
v_cvt_pk_bf16_f32 v27, v124, v125
ds_write_b64 v12, v[26:27] offset:11424
v_pk_mul_f32 v[42:43], v[76:77], v[40:41] op_sel:[0,0] op_sel_hi:[0,1]
v_pk_mul_f32 v[90:91], v[124:125], v[88:89] op_sel:[0,0] op_sel_hi:[0,1]
v_pk_fma_f32 v[74:75], v[76:77], v[40:41], v[42:43] op_sel:[1,1,0] op_sel_hi:[1,0,1] neg_lo:[1,0,0]
v_pk_fma_f32 v[122:123], v[124:125], v[88:89], v[90:91] op_sel:[1,1,0] op_sel_hi:[1,0,1] neg_lo:[1,0,0]
v_cvt_pk_bf16_f32 v28, v74, v75
v_cvt_pk_bf16_f32 v29, v122, v123
ds_write_b64 v12, v[28:29] offset:11968
v_pk_mul_f32 v[42:43], v[74:75], v[40:41] op_sel:[0,0] op_sel_hi:[0,1]
v_pk_mul_f32 v[90:91], v[122:123], v[88:89] op_sel:[0,0] op_sel_hi:[0,1]
v_pk_fma_f32 v[76:77], v[74:75], v[40:41], v[42:43] op_sel:[1,1,0] op_sel_hi:[1,0,1] neg_lo:[1,0,0]
v_pk_fma_f32 v[124:125], v[122:123], v[88:89], v[90:91] op_sel:[1,1,0] op_sel_hi:[1,0,1] neg_lo:[1,0,0]
v_cvt_pk_bf16_f32 v30, v76, v77
v_cvt_pk_bf16_f32 v31, v124, v125
ds_write_b64 v12, v[30:31] offset:12512
v_pk_mul_f32 v[42:43], v[76:77], v[40:41] op_sel:[0,0] op_sel_hi:[0,1]
v_pk_mul_f32 v[90:91], v[124:125], v[88:89] op_sel:[0,0] op_sel_hi:[0,1]
v_pk_fma_f32 v[74:75], v[76:77], v[40:41], v[42:43] op_sel:[1,1,0] op_sel_hi:[1,0,1] neg_lo:[1,0,0]
v_pk_fma_f32 v[122:123], v[124:125], v[88:89], v[90:91] op_sel:[1,1,0] op_sel_hi:[1,0,1] neg_lo:[1,0,0]
v_cvt_pk_bf16_f32 v24, v74, v75
v_cvt_pk_bf16_f32 v25, v122, v123
ds_write_b64 v12, v[24:25] offset:13056
ds_read_b128 v[160:163], v13 offset:8704
ds_read_b128 v[164:167], v13 offset:8768
ds_read_b128 v[168:171], v13 offset:8832
ds_read_b128 v[172:175], v13 offset:8896
ds_read_b128 v[176:179], v13 offset:8960
ds_read_b128 v[180:183], v13 offset:9024
ds_read_b128 v[184:187], v13 offset:9088
ds_read_b128 v[188:191], v13 offset:9152
v_mov_b32 v44, v36
v_mov_b32 v45, v37
v_mov_b32 v92, v84
v_mov_b32 v93, v85
v_pk_mul_f32 v[42:43], v[44:45], v[36:37] op_sel:[0,0] op_sel_hi:[0,1]
v_pk_mul_f32 v[90:91], v[92:93], v[84:85] op_sel:[0,0] op_sel_hi:[0,1]
v_pk_fma_f32 v[46:47], v[44:45], v[36:37], v[42:43] op_sel:[1,1,0] op_sel_hi:[1,0,1] neg_lo:[1,0,0]
v_pk_fma_f32 v[94:95], v[92:93], v[84:85], v[90:91] op_sel:[1,1,0] op_sel_hi:[1,0,1] neg_lo:[1,0,0]
s_waitcnt lgkmcnt(7)
v_mfma_f32_16x16x32_bf16 v[200:203], v[160:163], v[128:131], 0
s_waitcnt lgkmcnt(6)
v_mfma_f32_16x16x32_bf16 v[200:203], v[164:167], v[132:135], v[200:203]
v_pk_mul_f32 v[42:43], v[46:47], v[36:37] op_sel:[0,0] op_sel_hi:[0,1]
v_pk_mul_f32 v[90:91], v[94:95], v[84:85] op_sel:[0,0] op_sel_hi:[0,1]
v_pk_fma_f32 v[48:49], v[46:47], v[36:37], v[42:43] op_sel:[1,1,0] op_sel_hi:[1,0,1] neg_lo:[1,0,0]
v_pk_fma_f32 v[96:97], v[94:95], v[84:85], v[90:91] op_sel:[1,1,0] op_sel_hi:[1,0,1] neg_lo:[1,0,0]
s_waitcnt lgkmcnt(5)
v_mfma_f32_16x16x32_bf16 v[200:203], v[168:171], v[136:139], v[200:203]
s_waitcnt lgkmcnt(4)
v_mfma_f32_16x16x32_bf16 v[200:203], v[172:175], v[140:143], v[200:203]
v_pk_mul_f32 v[42:43], v[48:49], v[36:37] op_sel:[0,0] op_sel_hi:[0,1]
v_pk_mul_f32 v[90:91], v[96:97], v[84:85] op_sel:[0,0] op_sel_hi:[0,1]
v_pk_fma_f32 v[50:51], v[48:49], v[36:37], v[42:43] op_sel:[1,1,0] op_sel_hi:[1,0,1] neg_lo:[1,0,0]
v_pk_fma_f32 v[98:99], v[96:97], v[84:85], v[90:91] op_sel:[1,1,0] op_sel_hi:[1,0,1] neg_lo:[1,0,0]
s_waitcnt lgkmcnt(3)
v_mfma_f32_16x16x32_bf16 v[200:203], v[176:179], v[144:147], v[200:203]
s_waitcnt lgkmcnt(2)
v_mfma_f32_16x16x32_bf16 v[200:203], v[180:183], v[148:151], v[200:203]
v_pk_mul_f32 v[42:43], v[50:51], v[36:37] op_sel:[0,0] op_sel_hi:[0,1]
v_pk_mul_f32 v[90:91], v[98:99], v[84:85] op_sel:[0,0] op_sel_hi:[0,1]
v_pk_fma_f32 v[52:53], v[50:51], v[36:37], v[42:43] op_sel:[1,1,0] op_sel_hi:[1,0,1] neg_lo:[1,0,0]
v_pk_fma_f32 v[100:101], v[98:99], v[84:85], v[90:91] op_sel:[1,1,0] op_sel_hi:[1,0,1] neg_lo:[1,0,0]
s_waitcnt lgkmcnt(1)
v_mfma_f32_16x16x32_bf16 v[200:203], v[184:187], v[152:155], v[200:203]
s_waitcnt lgkmcnt(0)
v_mfma_f32_16x16x32_bf16 v[200:203], v[188:191], v[156:159], v[200:203]
v_pk_mul_f32 v[42:43], v[52:53], v[36:37] op_sel:[0,0] op_sel_hi:[0,1]
v_pk_mul_f32 v[90:91], v[100:101], v[84:85] op_sel:[0,0] op_sel_hi:[0,1]
v_pk_fma_f32 v[54:55], v[52:53], v[36:37], v[42:43] op_sel:[1,1,0] op_sel_hi:[1,0,1] neg_lo:[1,0,0]
v_pk_fma_f32 v[102:103], v[100:101], v[84:85], v[90:91] op_sel:[1,1,0] op_sel_hi:[1,0,1] neg_lo:[1,0,0]
v_pk_mul_f32 v[42:43], v[54:55], v[36:37] op_sel:[0,0] op_sel_hi:[0,1]
v_pk_mul_f32 v[90:91], v[102:103], v[84:85] op_sel:[0,0] op_sel_hi:[0,1]
v_pk_fma_f32 v[56:57], v[54:55], v[36:37], v[42:43] op_sel:[1,1,0] op_sel_hi:[1,0,1] neg_lo:[1,0,0]
v_pk_fma_f32 v[104:105], v[102:103], v[84:85], v[90:91] op_sel:[1,1,0] op_sel_hi:[1,0,1] neg_lo:[1,0,0]
v_cvt_pk_bf16_f32 v26, v58, v59
v_cvt_pk_bf16_f32 v27, v106, v107
ds_write_b64 v12, v[26:27] offset:8704
v_pk_mul_f32 v[42:43], v[58:59], v[46:47] op_sel:[0,0] op_sel_hi:[0,1]
v_pk_mul_f32 v[90:91], v[106:107], v[94:95] op_sel:[0,0] op_sel_hi:[0,1]
v_pk_fma_f32 v[72:73], v[58:59], v[46:47], v[42:43] op_sel:[1,1,0] op_sel_hi:[1,0,1] neg_lo:[1,0,0]
v_pk_fma_f32 v[120:121], v[106:107], v[94:95], v[90:91] op_sel:[1,1,0] op_sel_hi:[1,0,1] neg_lo:[1,0,0]
v_cvt_pk_bf16_f32 v28, v72, v73
v_cvt_pk_bf16_f32 v29, v120, v121
ds_write_b64 v12, v[28:29] offset:9248
v_pk_mul_f32 v[42:43], v[58:59], v[50:51] op_sel:[0,0] op_sel_hi:[0,1]
v_pk_mul_f32 v[90:91], v[106:107], v[98:99] op_sel:[0,0] op_sel_hi:[0,1]
v_pk_fma_f32 v[70:71], v[58:59], v[50:51], v[42:43] op_sel:[1,1,0] op_sel_hi:[1,0,1] neg_lo:[1,0,0]
v_pk_fma_f32 v[118:119], v[106:107], v[98:99], v[90:91] op_sel:[1,1,0] op_sel_hi:[1,0,1] neg_lo:[1,0,0]
v_cvt_pk_bf16_f32 v30, v70, v71
v_cvt_pk_bf16_f32 v31, v118, v119
ds_write_b64 v12, v[30:31] offset:9792
v_pk_mul_f32 v[42:43], v[58:59], v[54:55] op_sel:[0,0] op_sel_hi:[0,1]
v_pk_mul_f32 v[90:91], v[106:107], v[102:103] op_sel:[0,0] op_sel_hi:[0,1]
v_pk_fma_f32 v[72:73], v[58:59], v[54:55], v[42:43] op_sel:[1,1,0] op_sel_hi:[1,0,1] neg_lo:[1,0,0]
v_pk_fma_f32 v[120:121], v[106:107], v[102:103], v[90:91] op_sel:[1,1,0] op_sel_hi:[1,0,1] neg_lo:[1,0,0]
v_cvt_pk_bf16_f32 v24, v72, v73
v_cvt_pk_bf16_f32 v25, v120, v121
ds_write_b64 v12, v[24:25] offset:10336
v_cvt_pk_bf16_f32 v26, v60, v61
v_cvt_pk_bf16_f32 v27, v108, v109
ds_write_b64 v12, v[26:27] offset:10880
v_pk_mul_f32 v[42:43], v[60:61], v[46:47] op_sel:[0,0] op_sel_hi:[0,1]
v_pk_mul_f32 v[90:91], v[108:109], v[94:95] op_sel:[0,0] op_sel_hi:[0,1]
v_pk_fma_f32 v[72:73], v[60:61], v[46:47], v[42:43] op_sel:[1,1,0] op_sel_hi:[1,0,1] neg_lo:[1,0,0]
v_pk_fma_f32 v[120:121], v[108:109], v[94:95], v[90:91] op_sel:[1,1,0] op_sel_hi:[1,0,1] neg_lo:[1,0,0]
v_cvt_pk_bf16_f32 v28, v72, v73
v_cvt_pk_bf16_f32 v29, v120, v121
ds_write_b64 v12, v[28:29] offset:11424
v_pk_mul_f32 v[42:43], v[60:61], v[50:51] op_sel:[0,0] op_sel_hi:[0,1]
v_pk_mul_f32 v[90:91], v[108:109], v[98:99] op_sel:[0,0] op_sel_hi:[0,1]
v_pk_fma_f32 v[70:71], v[60:61], v[50:51], v[42:43] op_sel:[1,1,0] op_sel_hi:[1,0,1] neg_lo:[1,0,0]
v_pk_fma_f32 v[118:119], v[108:109], v[98:99], v[90:91] op_sel:[1,1,0] op_sel_hi:[1,0,1] neg_lo:[1,0,0]
v_cvt_pk_bf16_f32 v30, v70, v71
v_cvt_pk_bf16_f32 v31, v118, v119
ds_write_b64 v12, v[30:31] offset:11968
v_pk_mul_f32 v[42:43], v[60:61], v[54:55] op_sel:[0,0] op_sel_hi:[0,1]
v_pk_mul_f32 v[90:91], v[108:109], v[102:103] op_sel:[0,0] op_sel_hi:[0,1]
v_pk_fma_f32 v[72:73], v[60:61], v[54:55], v[42:43] op_sel:[1,1,0] op_sel_hi:[1,0,1] neg_lo:[1,0,0]
v_pk_fma_f32 v[120:121], v[108:109], v[102:103], v[90:91] op_sel:[1,1,0] op_sel_hi:[1,0,1] neg_lo:[1,0,0]
v_cvt_pk_bf16_f32 v24, v72, v73
v_cvt_pk_bf16_f32 v25, v120, v121
ds_write_b64 v12, v[24:25] offset:12512
ds_write_b32 v243, v200 offset:1024
ds_write_b32 v243, v201 offset:1088
ds_write_b32 v243, v202 offset:1152
ds_write_b32 v243, v203 offset:1216
v_cvt_pk_bf16_f32 v26, v62, v63
v_cvt_pk_bf16_f32 v27, v110, v111
ds_write_b64 v12, v[26:27] offset:13056
v_pk_mul_f32 v[42:43], v[62:63], v[50:51] op_sel:[0,0] op_sel_hi:[0,1]
v_pk_mul_f32 v[90:91], v[110:111], v[98:99] op_sel:[0,0] op_sel_hi:[0,1]
v_pk_fma_f32 v[72:73], v[62:63], v[50:51], v[42:43] op_sel:[1,1,0] op_sel_hi:[1,0,1] neg_lo:[1,0,0]
v_pk_fma_f32 v[120:121], v[110:111], v[98:99], v[90:91] op_sel:[1,1,0] op_sel_hi:[1,0,1] neg_lo:[1,0,0]
v_cvt_pk_bf16_f32 v28, v72, v73
v_cvt_pk_bf16_f32 v29, v120, v121
ds_write_b64 v12, v[28:29] offset:13600
v_cvt_pk_bf16_f32 v30, v64, v65
v_cvt_pk_bf16_f32 v31, v112, v113
ds_write_b64 v12, v[30:31] offset:14144
v_pk_mul_f32 v[42:43], v[64:65], v[50:51] op_sel:[0,0] op_sel_hi:[0,1]
v_pk_mul_f32 v[90:91], v[112:113], v[98:99] op_sel:[0,0] op_sel_hi:[0,1]
v_pk_fma_f32 v[72:73], v[64:65], v[50:51], v[42:43] op_sel:[1,1,0] op_sel_hi:[1,0,1] neg_lo:[1,0,0]
v_pk_fma_f32 v[120:121], v[112:113], v[98:99], v[90:91] op_sel:[1,1,0] op_sel_hi:[1,0,1] neg_lo:[1,0,0]
v_cvt_pk_bf16_f32 v24, v72, v73
v_cvt_pk_bf16_f32 v25, v120, v121
ds_write_b64 v12, v[24:25] offset:14688
v_cvt_pk_bf16_f32 v26, v66, v67
v_cvt_pk_bf16_f32 v27, v114, v115
ds_write_b64 v12, v[26:27] offset:15232
v_pk_mul_f32 v[42:43], v[66:67], v[50:51] op_sel:[0,0] op_sel_hi:[0,1]
v_pk_mul_f32 v[90:91], v[114:115], v[98:99] op_sel:[0,0] op_sel_hi:[0,1]
v_pk_fma_f32 v[72:73], v[66:67], v[50:51], v[42:43] op_sel:[1,1,0] op_sel_hi:[1,0,1] neg_lo:[1,0,0]
v_pk_fma_f32 v[120:121], v[114:115], v[98:99], v[90:91] op_sel:[1,1,0] op_sel_hi:[1,0,1] neg_lo:[1,0,0]
v_cvt_pk_bf16_f32 v28, v72, v73
v_cvt_pk_bf16_f32 v29, v120, v121
ds_write_b64 v12, v[28:29] offset:15776
v_cvt_pk_bf16_f32 v30, v68, v69
v_cvt_pk_bf16_f32 v31, v116, v117
ds_write_b64 v12, v[30:31] offset:16320
v_pk_mul_f32 v[42:43], v[68:69], v[50:51] op_sel:[0,0] op_sel_hi:[0,1]
v_pk_mul_f32 v[90:91], v[116:117], v[98:99] op_sel:[0,0] op_sel_hi:[0,1]
v_pk_fma_f32 v[72:73], v[68:69], v[50:51], v[42:43] op_sel:[1,1,0] op_sel_hi:[1,0,1] neg_lo:[1,0,0]
v_pk_fma_f32 v[120:121], v[116:117], v[98:99], v[90:91] op_sel:[1,1,0] op_sel_hi:[1,0,1] neg_lo:[1,0,0]
v_cvt_pk_bf16_f32 v24, v72, v73
v_cvt_pk_bf16_f32 v25, v120, v121
ds_write_b64 v12, v[24:25] offset:16864
ds_read_b128 v[160:163], v13 offset:8704
ds_read_b128 v[164:167], v13 offset:8768
ds_read_b128 v[168:171], v13 offset:8832
ds_read_b128 v[172:175], v13 offset:8896
ds_read_b128 v[176:179], v13 offset:8960
ds_read_b128 v[180:183], v13 offset:9024
ds_read_b128 v[184:187], v13 offset:9088
ds_read_b128 v[188:191], v13 offset:9152
v_mov_b32 v26, 0x3f80
v_mov_b32 v27, 0x3f80
ds_write_b64 v12, v[26:27] offset:8704
s_waitcnt lgkmcnt(8)
v_mfma_f32_16x16x32_bf16 v[196:199], v[160:163], v[128:131], 0
ds_read_b32 v204, v246 offset:1024
ds_read_b32 v205, v246 offset:1028
ds_read_b32 v206, v246 offset:1280
ds_read_b32 v207, v246 offset:1284
v_cvt_pk_bf16_f32 v28, v44, v45
v_cvt_pk_bf16_f32 v29, v92, v93
ds_write_b64 v12, v[28:29] offset:9248
s_waitcnt lgkmcnt(12)
v_mfma_f32_16x16x32_bf16 v[196:199], v[164:167], v[132:135], v[196:199]
v_cvt_pk_bf16_f32 v30, v46, v47
v_cvt_pk_bf16_f32 v31, v94, v95
ds_write_b64 v12, v[30:31] offset:9792
s_waitcnt lgkmcnt(12)
v_mfma_f32_16x16x32_bf16 v[196:199], v[168:171], v[136:139], v[196:199]
v_cvt_pk_bf16_f32 v24, v48, v49
v_cvt_pk_bf16_f32 v25, v96, v97
ds_write_b64 v12, v[24:25] offset:10336
s_waitcnt lgkmcnt(12)
v_mfma_f32_16x16x32_bf16 v[196:199], v[172:175], v[140:143], v[196:199]
v_cvt_pk_bf16_f32 v26, v50, v51
v_cvt_pk_bf16_f32 v27, v98, v99
ds_write_b64 v12, v[26:27] offset:10880
s_waitcnt lgkmcnt(12)
v_mfma_f32_16x16x32_bf16 v[196:199], v[176:179], v[144:147], v[196:199]
v_cvt_pk_bf16_f32 v28, v52, v53
v_cvt_pk_bf16_f32 v29, v100, v101
ds_write_b64 v12, v[28:29] offset:11424
s_waitcnt lgkmcnt(12)
v_mfma_f32_16x16x32_bf16 v[196:199], v[180:183], v[148:151], v[196:199]
v_cvt_pk_bf16_f32 v30, v54, v55
v_cvt_pk_bf16_f32 v31, v102, v103
ds_write_b64 v12, v[30:31] offset:11968
s_waitcnt lgkmcnt(12)
v_mfma_f32_16x16x32_bf16 v[196:199], v[184:187], v[152:155], v[196:199]
v_cvt_pk_bf16_f32 v24, v56, v57
v_cvt_pk_bf16_f32 v25, v104, v105
ds_write_b64 v12, v[24:25] offset:12512
s_waitcnt lgkmcnt(12)
v_mfma_f32_16x16x32_bf16 v[196:199], v[188:191], v[156:159], v[196:199]
v_cvt_pk_bf16_f32 v26, v40, v41
v_cvt_pk_bf16_f32 v27, v88, v89
ds_write_b64 v12, v[26:27] offset:13056
s_waitcnt lgkmcnt(8)
v_and_b32 v16, 1, v1
v_cmp_eq_u32 vcc, 0, v16
s_nop 1
v_cndmask_b32 v16, v205, v204, vcc
v_cvt_pk_bf16_f32 v208, v204, v204
v_cvt_pk_bf16_f32 v210, v16, v205
v_cvt_pk_bf16_f32 v211, v205, v205
v_mov_b32 v209, v208
ds_write_b128 v247, v[208:211] offset:2048
v_cndmask_b32 v16, v207, v206, vcc
v_cvt_pk_bf16_f32 v212, v206, v206
v_cvt_pk_bf16_f32 v214, v16, v207
v_cvt_pk_bf16_f32 v215, v207, v207
v_mov_b32 v213, v212
ds_write_b128 v247, v[212:215] offset:3072
ds_write_b64 v241, v[196:197]
ds_write_b64 v242, v[198:199]
v_pk_mul_f32 v[42:43], v[40:41], v[44:45] op_sel:[0,0] op_sel_hi:[0,1]
v_pk_mul_f32 v[90:91], v[88:89], v[92:93] op_sel:[0,0] op_sel_hi:[0,1]
v_pk_fma_f32 v[72:73], v[40:41], v[44:45], v[42:43] op_sel:[1,1,0] op_sel_hi:[1,0,1] neg_lo:[1,0,0]
v_pk_fma_f32 v[120:121], v[88:89], v[92:93], v[90:91] op_sel:[1,1,0] op_sel_hi:[1,0,1] neg_lo:[1,0,0]
v_cvt_pk_bf16_f32 v28, v72, v73
v_cvt_pk_bf16_f32 v29, v120, v121
ds_write_b64 v12, v[28:29] offset:13600
s_mov_b64 exec, 0xffffffff
ds_read_b128 v[216:219], v244
ds_read_b32 v220, v244 offset:16
s_mov_b64 exec, -1
ds_read_b64 v[222:223], v245 offset:512
ds_read_b32 v224, v245 offset:520
v_pk_mul_f32 v[42:43], v[40:41], v[46:47] op_sel:[0,0] op_sel_hi:[0,1]
v_pk_mul_f32 v[90:91], v[88:89], v[94:95] op_sel:[0,0] op_sel_hi:[0,1]
v_pk_fma_f32 v[70:71], v[40:41], v[46:47], v[42:43] op_sel:[1,1,0] op_sel_hi:[1,0,1] neg_lo:[1,0,0]
v_pk_fma_f32 v[118:119], v[88:89], v[94:95], v[90:91] op_sel:[1,1,0] op_sel_hi:[1,0,1] neg_lo:[1,0,0]
v_cvt_pk_bf16_f32 v30, v70, v71
v_cvt_pk_bf16_f32 v31, v118, v119
ds_write_b64 v12, v[30:31] offset:14144
v_pk_mul_f32 v[42:43], v[40:41], v[48:49] op_sel:[0,0] op_sel_hi:[0,1]
v_pk_mul_f32 v[90:91], v[88:89], v[96:97] op_sel:[0,0] op_sel_hi:[0,1]
v_pk_fma_f32 v[72:73], v[40:41], v[48:49], v[42:43] op_sel:[1,1,0] op_sel_hi:[1,0,1] neg_lo:[1,0,0]
v_pk_fma_f32 v[120:121], v[88:89], v[96:97], v[90:91] op_sel:[1,1,0] op_sel_hi:[1,0,1] neg_lo:[1,0,0]
v_cvt_pk_bf16_f32 v24, v72, v73
v_cvt_pk_bf16_f32 v25, v120, v121
ds_write_b64 v12, v[24:25] offset:14688
v_pk_mul_f32 v[42:43], v[40:41], v[50:51] op_sel:[0,0] op_sel_hi:[0,1]
v_pk_mul_f32 v[90:91], v[88:89], v[98:99] op_sel:[0,0] op_sel_hi:[0,1]
v_pk_fma_f32 v[70:71], v[40:41], v[50:51], v[42:43] op_sel:[1,1,0] op_sel_hi:[1,0,1] neg_lo:[1,0,0]
v_pk_fma_f32 v[118:119], v[88:89], v[98:99], v[90:91] op_sel:[1,1,0] op_sel_hi:[1,0,1] neg_lo:[1,0,0]
v_cvt_pk_bf16_f32 v26, v70, v71
v_cvt_pk_bf16_f32 v27, v118, v119
ds_write_b64 v12, v[26:27] offset:15232
s_waitcnt lgkmcnt(3)
v_cvt_pk_bf16_f32 v208, v216, v216
v_cvt_pk_bf16_f32 v209, v217, v218
v_cvt_pk_bf16_f32 v210, v218, v218
v_cvt_pk_bf16_f32 v211, v219, v220
s_mov_b64 exec, 0xffffffff
ds_write_b128 v247, v[208:211] offset:512
s_mov_b64 exec, -1
v_cvt_pk_bf16_f32 v212, v222, v222
v_cvt_pk_bf16_f32 v213, v222, v223
v_cvt_pk_bf16_f32 v214, v223, v223
v_cvt_pk_bf16_f32 v215, v224, v224
ds_write_b128 v247, v[212:215] offset:1024
v_pk_mul_f32 v[42:43], v[40:41], v[52:53] op_sel:[0,0] op_sel_hi:[0,1]
v_pk_mul_f32 v[90:91], v[88:89], v[100:101] op_sel:[0,0] op_sel_hi:[0,1]
v_pk_fma_f32 v[72:73], v[40:41], v[52:53], v[42:43] op_sel:[1,1,0] op_sel_hi:[1,0,1] neg_lo:[1,0,0]
v_pk_fma_f32 v[120:121], v[88:89], v[100:101], v[90:91] op_sel:[1,1,0] op_sel_hi:[1,0,1] neg_lo:[1,0,0]
v_cvt_pk_bf16_f32 v28, v72, v73
v_cvt_pk_bf16_f32 v29, v120, v121
ds_write_b64 v12, v[28:29] offset:15776
v_pk_mul_f32 v[42:43], v[40:41], v[54:55] op_sel:[0,0] op_sel_hi:[0,1]
v_pk_mul_f32 v[90:91], v[88:89], v[102:103] op_sel:[0,0] op_sel_hi:[0,1]
v_pk_fma_f32 v[70:71], v[40:41], v[54:55], v[42:43] op_sel:[1,1,0] op_sel_hi:[1,0,1] neg_lo:[1,0,0]
v_pk_fma_f32 v[118:119], v[88:89], v[102:103], v[90:91] op_sel:[1,1,0] op_sel_hi:[1,0,1] neg_lo:[1,0,0]
v_cvt_pk_bf16_f32 v30, v70, v71
v_cvt_pk_bf16_f32 v31, v118, v119
ds_write_b64 v12, v[30:31] offset:16320
v_pk_mul_f32 v[42:43], v[40:41], v[56:57] op_sel:[0,0] op_sel_hi:[0,1]
v_pk_mul_f32 v[90:91], v[88:89], v[104:105] op_sel:[0,0] op_sel_hi:[0,1]
v_pk_fma_f32 v[72:73], v[40:41], v[56:57], v[42:43] op_sel:[1,1,0] op_sel_hi:[1,0,1] neg_lo:[1,0,0]
v_pk_fma_f32 v[120:121], v[88:89], v[104:105], v[90:91] op_sel:[1,1,0] op_sel_hi:[1,0,1] neg_lo:[1,0,0]
v_cvt_pk_bf16_f32 v24, v72, v73
v_cvt_pk_bf16_f32 v25, v120, v121
ds_write_b64 v12, v[24:25] offset:16864
ds_read_b128 v[160:163], v13 offset:8704
ds_read_b128 v[164:167], v13 offset:8768
ds_read_b128 v[168:171], v13 offset:8832
ds_read_b128 v[172:175], v13 offset:8896
ds_read_b128 v[176:179], v13 offset:8960
ds_read_b128 v[180:183], v13 offset:9024
ds_read_b128 v[184:187], v13 offset:9088
ds_read_b128 v[188:191], v13 offset:9152
v_mov_b32 v64, 0
v_mov_b32 v65, 0
v_mov_b32 v66, 0
v_mov_b32 v67, 0
s_waitcnt lgkmcnt(7)
v_mfma_f32_16x16x32_bf16 v[192:195], v[160:163], v[128:131], 0
v_mov_b32 v68, 0
v_mov_b32 v69, 0
v_mov_b32 v70, 0
v_mov_b32 v71, 0
s_waitcnt lgkmcnt(6)
v_mfma_f32_16x16x32_bf16 v[192:195], v[164:167], v[132:135], v[192:195]
v_mov_b32 v72, 0
v_mov_b32 v73, 0
v_mov_b32 v74, 0
v_mov_b32 v75, 0
s_waitcnt lgkmcnt(5)
v_mfma_f32_16x16x32_bf16 v[192:195], v[168:171], v[136:139], v[192:195]
v_mov_b32 v76, 0
v_mov_b32 v77, 0
v_mov_b32 v78, 0
v_mov_b32 v79, 0
s_waitcnt lgkmcnt(4)
v_mfma_f32_16x16x32_bf16 v[192:195], v[172:175], v[140:143], v[192:195]
v_mov_b32 v80, 0
v_mov_b32 v81, 0
v_mov_b32 v82, 0
v_mov_b32 v83, 0
s_waitcnt lgkmcnt(3)
v_mfma_f32_16x16x32_bf16 v[192:195], v[176:179], v[144:147], v[192:195]
v_mov_b32 v84, 0
v_mov_b32 v85, 0
v_mov_b32 v86, 0
v_mov_b32 v87, 0
s_waitcnt lgkmcnt(2)
v_mfma_f32_16x16x32_bf16 v[192:195], v[180:183], v[148:151], v[192:195]
v_mov_b32 v88, 0
v_mov_b32 v89, 0
v_mov_b32 v90, 0
v_mov_b32 v91, 0
s_waitcnt lgkmcnt(1)
v_mfma_f32_16x16x32_bf16 v[192:195], v[184:187], v[152:155], v[192:195]
v_mov_b32 v92, 0
v_mov_b32 v93, 0
v_mov_b32 v94, 0
v_mov_b32 v95, 0
s_waitcnt lgkmcnt(0)
v_mfma_f32_16x16x32_bf16 v[192:195], v[188:191], v[156:159], v[192:195]
s_nop 7
v_add_f32 v192, v192, v19
v_cvt_pk_bf16_f32 v20, v192, v193
v_cvt_pk_bf16_f32 v21, v194, v195
ds_write_b64 v240, v[20:21]
s_waitcnt lgkmcnt(0)
s_barrier
ds_read_b64 v[96:97], v248 offset:4032
ds_read_b64 v[98:99], v248 offset:4040
ds_read_b128 v[128:131], v249 offset:448
ds_read_b64 v[100:101], v248 offset:3520
ds_read_b64 v[102:103], v248 offset:3528
ds_read_b128 v[132:135], v249 offset:960
ds_read_b64 v[104:105], v248 offset:3008
ds_read_b64 v[106:107], v248 offset:3016
ds_read_b128 v[136:139], v249 offset:1472
ds_read_b64 v[108:109], v248 offset:2496
ds_read_b64 v[110:111], v248 offset:2504
ds_read_b128 v[140:143], v249 offset:1984
ds_read_b128 v[144:147], v249 offset:2496
ds_read_b128 v[148:151], v249 offset:3008
ds_read_b128 v[152:155], v249 offset:3520
ds_read_b128 v[156:159], v249 offset:4032
s_waitcnt lgkmcnt(13)
v_mfma_f32_16x16x32_bf16 v[64:67], v[96:99], v[128:131], v[64:67]
s_waitcnt lgkmcnt(10)
v_mfma_f32_16x16x32_bf16 v[68:71], v[96:99], v[132:135], v[68:71]
v_mfma_f32_16x16x32_bf16 v[68:71], v[100:103], v[128:131], v[68:71]
ds_read_b64 v[112:113], v248 offset:3968
v_mfma_f32_16x16x32_bf16 v[72:75], v[100:103], v[132:135], v[72:75]
ds_read_b64 v[114:115], v248 offset:3976
s_waitcnt lgkmcnt(9)
v_mfma_f32_16x16x32_bf16 v[72:75], v[96:99], v[136:139], v[72:75]
ds_read_b128 v[160:163], v249 offset:384
v_mfma_f32_16x16x32_bf16 v[76:79], v[100:103], v[136:139], v[76:79]
ds_read_b64 v[116:117], v248 offset:3456
v_mfma_f32_16x16x32_bf16 v[72:75], v[104:107], v[128:131], v[72:75]
ds_read_b64 v[118:119], v248 offset:3464
v_mfma_f32_16x16x32_bf16 v[76:79], v[104:107], v[132:135], v[76:79]
ds_read_b128 v[164:167], v249 offset:896
v_mfma_f32_16x16x32_bf16 v[80:83], v[104:107], v[136:139], v[80:83]
ds_read_b64 v[120:121], v248 offset:2944
s_waitcnt lgkmcnt(11)
v_mfma_f32_16x16x32_bf16 v[76:79], v[96:99], v[140:143], v[76:79]
ds_read_b64 v[122:123], v248 offset:2952
v_mfma_f32_16x16x32_bf16 v[80:83], v[100:103], v[140:143], v[80:83]
ds_read_b128 v[168:171], v249 offset:1408
v_mfma_f32_16x16x32_bf16 v[84:87], v[104:107], v[140:143], v[84:87]
ds_read_b64 v[124:125], v248 offset:2432
v_mfma_f32_16x16x32_bf16 v[76:79], v[108:111], v[128:131], v[76:79]
ds_read_b64 v[126:127], v248 offset:2440
v_mfma_f32_16x16x32_bf16 v[80:83], v[108:111], v[132:135], v[80:83]
ds_read_b128 v[172:175], v249 offset:1920
v_mfma_f32_16x16x32_bf16 v[84:87], v[108:111], v[136:139], v[84:87]
ds_read_b128 v[176:179], v249 offset:2432
v_mfma_f32_16x16x32_bf16 v[88:91], v[108:111], v[140:143], v[88:91]
ds_read_b128 v[180:183], v249 offset:2944
s_waitcnt lgkmcnt(15)
v_mfma_f32_16x16x32_bf16 v[80:83], v[96:99], v[144:147], v[80:83]
ds_read_b128 v[184:187], v249 offset:3456
v_mfma_f32_16x16x32_bf16 v[84:87], v[100:103], v[144:147], v[84:87]
ds_read_b128 v[188:191], v249 offset:3968
v_mfma_f32_16x16x32_bf16 v[88:91], v[104:107], v[144:147], v[88:91]
v_mfma_f32_16x16x32_bf16 v[92:95], v[108:111], v[144:147], v[92:95]
v_mfma_f32_16x16x32_bf16 v[84:87], v[96:99], v[148:151], v[84:87]
v_mfma_f32_16x16x32_bf16 v[88:91], v[100:103], v[148:151], v[88:91]
v_mfma_f32_16x16x32_bf16 v[92:95], v[104:107], v[148:151], v[92:95]
v_mfma_f32_16x16x32_bf16 v[88:91], v[96:99], v[152:155], v[88:91]
v_mfma_f32_16x16x32_bf16 v[92:95], v[100:103], v[152:155], v[92:95]
s_waitcnt lgkmcnt(15)
v_mfma_f32_16x16x32_bf16 v[92:95], v[96:99], v[156:159], v[92:95]
s_waitcnt lgkmcnt(13)
v_mfma_f32_16x16x32_bf16 v[64:67], v[112:115], v[160:163], v[64:67]
s_waitcnt lgkmcnt(10)
v_mfma_f32_16x16x32_bf16 v[68:71], v[112:115], v[164:167], v[68:71]
v_mfma_f32_16x16x32_bf16 v[68:71], v[116:119], v[160:163], v[68:71]
ds_read_b64 v[96:97], v248 offset:3904
v_mfma_f32_16x16x32_bf16 v[72:75], v[116:119], v[164:167], v[72:75]
ds_read_b64 v[98:99], v248 offset:3912
s_waitcnt lgkmcnt(9)
v_mfma_f32_16x16x32_bf16 v[72:75], v[112:115], v[168:171], v[72:75]
ds_read_b128 v[128:131], v249 offset:320
v_mfma_f32_16x16x32_bf16 v[76:79], v[116:119], v[168:171], v[76:79]
ds_read_b64 v[100:101], v248 offset:3392
v_mfma_f32_16x16x32_bf16 v[72:75], v[120:123], v[160:163], v[72:75]
ds_read_b64 v[102:103], v248 offset:3400
v_mfma_f32_16x16x32_bf16 v[76:79], v[120:123], v[164:167], v[76:79]
ds_read_b128 v[132:135], v249 offset:832
v_mfma_f32_16x16x32_bf16 v[80:83], v[120:123], v[168:171], v[80:83]
ds_read_b64 v[104:105], v248 offset:2880
s_waitcnt lgkmcnt(11)
v_mfma_f32_16x16x32_bf16 v[76:79], v[112:115], v[172:175], v[76:79]
ds_read_b64 v[106:107], v248 offset:2888
v_mfma_f32_16x16x32_bf16 v[80:83], v[116:119], v[172:175], v[80:83]
ds_read_b128 v[136:139], v249 offset:1344
v_mfma_f32_16x16x32_bf16 v[84:87], v[120:123], v[172:175], v[84:87]
ds_read_b64 v[108:109], v248 offset:2368
v_mfma_f32_16x16x32_bf16 v[76:79], v[124:127], v[160:163], v[76:79]
ds_read_b64 v[110:111], v248 offset:2376
v_mfma_f32_16x16x32_bf16 v[80:83], v[124:127], v[164:167], v[80:83]
ds_read_b128 v[140:143], v249 offset:1856
v_mfma_f32_16x16x32_bf16 v[84:87], v[124:127], v[168:171], v[84:87]
ds_read_b128 v[144:147], v249 offset:2368
v_mfma_f32_16x16x32_bf16 v[88:91], v[124:127], v[172:175], v[88:91]
ds_read_b128 v[148:151], v249 offset:2880
s_waitcnt lgkmcnt(15)
v_mfma_f32_16x16x32_bf16 v[80:83], v[112:115], v[176:179], v[80:83]
ds_read_b128 v[152:155], v249 offset:3392
v_mfma_f32_16x16x32_bf16 v[84:87], v[116:119], v[176:179], v[84:87]
ds_read_b128 v[156:159], v249 offset:3904
v_mfma_f32_16x16x32_bf16 v[88:91], v[120:123], v[176:179], v[88:91]
v_mfma_f32_16x16x32_bf16 v[92:95], v[124:127], v[176:179], v[92:95]
v_mfma_f32_16x16x32_bf16 v[84:87], v[112:115], v[180:183], v[84:87]
v_mfma_f32_16x16x32_bf16 v[88:91], v[116:119], v[180:183], v[88:91]
v_mfma_f32_16x16x32_bf16 v[92:95], v[120:123], v[180:183], v[92:95]
v_mfma_f32_16x16x32_bf16 v[88:91], v[112:115], v[184:187], v[88:91]
v_mfma_f32_16x16x32_bf16 v[92:95], v[116:119], v[184:187], v[92:95]
s_waitcnt lgkmcnt(15)
v_mfma_f32_16x16x32_bf16 v[92:95], v[112:115], v[188:191], v[92:95]
s_waitcnt lgkmcnt(13)
v_mfma_f32_16x16x32_bf16 v[64:67], v[96:99], v[128:131], v[64:67]
s_waitcnt lgkmcnt(10)
v_mfma_f32_16x16x32_bf16 v[68:71], v[96:99], v[132:135], v[68:71]
v_mfma_f32_16x16x32_bf16 v[68:71], v[100:103], v[128:131], v[68:71]
ds_read_b64 v[112:113], v248 offset:3840
v_mfma_f32_16x16x32_bf16 v[72:75], v[100:103], v[132:135], v[72:75]
ds_read_b64 v[114:115], v248 offset:3848
s_waitcnt lgkmcnt(9)
v_mfma_f32_16x16x32_bf16 v[72:75], v[96:99], v[136:139], v[72:75]
ds_read_b128 v[160:163], v249 offset:256
v_mfma_f32_16x16x32_bf16 v[76:79], v[100:103], v[136:139], v[76:79]
ds_read_b64 v[116:117], v248 offset:3328
v_mfma_f32_16x16x32_bf16 v[72:75], v[104:107], v[128:131], v[72:75]
ds_read_b64 v[118:119], v248 offset:3336
v_mfma_f32_16x16x32_bf16 v[76:79], v[104:107], v[132:135], v[76:79]
ds_read_b128 v[164:167], v249 offset:768
v_mfma_f32_16x16x32_bf16 v[80:83], v[104:107], v[136:139], v[80:83]
ds_read_b64 v[120:121], v248 offset:2816
s_waitcnt lgkmcnt(11)
v_mfma_f32_16x16x32_bf16 v[76:79], v[96:99], v[140:143], v[76:79]
ds_read_b64 v[122:123], v248 offset:2824
v_mfma_f32_16x16x32_bf16 v[80:83], v[100:103], v[140:143], v[80:83]
ds_read_b128 v[168:171], v249 offset:1280
v_mfma_f32_16x16x32_bf16 v[84:87], v[104:107], v[140:143], v[84:87]
ds_read_b64 v[124:125], v248 offset:2304
v_mfma_f32_16x16x32_bf16 v[76:79], v[108:111], v[128:131], v[76:79]
ds_read_b64 v[126:127], v248 offset:2312
v_mfma_f32_16x16x32_bf16 v[80:83], v[108:111], v[132:135], v[80:83]
ds_read_b128 v[172:175], v249 offset:1792
v_mfma_f32_16x16x32_bf16 v[84:87], v[108:111], v[136:139], v[84:87]
ds_read_b128 v[176:179], v249 offset:2304
v_mfma_f32_16x16x32_bf16 v[88:91], v[108:111], v[140:143], v[88:91]
ds_read_b128 v[180:183], v249 offset:2816
s_waitcnt lgkmcnt(15)
v_mfma_f32_16x16x32_bf16 v[80:83], v[96:99], v[144:147], v[80:83]
ds_read_b128 v[184:187], v249 offset:3328
v_mfma_f32_16x16x32_bf16 v[84:87], v[100:103], v[144:147], v[84:87]
ds_read_b128 v[188:191], v249 offset:3840
v_mfma_f32_16x16x32_bf16 v[88:91], v[104:107], v[144:147], v[88:91]
v_mfma_f32_16x16x32_bf16 v[92:95], v[108:111], v[144:147], v[92:95]
v_mfma_f32_16x16x32_bf16 v[84:87], v[96:99], v[148:151], v[84:87]
v_mfma_f32_16x16x32_bf16 v[88:91], v[100:103], v[148:151], v[88:91]
v_mfma_f32_16x16x32_bf16 v[92:95], v[104:107], v[148:151], v[92:95]
v_mfma_f32_16x16x32_bf16 v[88:91], v[96:99], v[152:155], v[88:91]
v_mfma_f32_16x16x32_bf16 v[92:95], v[100:103], v[152:155], v[92:95]
s_waitcnt lgkmcnt(15)
v_mfma_f32_16x16x32_bf16 v[92:95], v[96:99], v[156:159], v[92:95]
s_waitcnt lgkmcnt(13)
v_mfma_f32_16x16x32_bf16 v[64:67], v[112:115], v[160:163], v[64:67]
s_waitcnt lgkmcnt(10)
v_mfma_f32_16x16x32_bf16 v[68:71], v[112:115], v[164:167], v[68:71]
v_mfma_f32_16x16x32_bf16 v[68:71], v[116:119], v[160:163], v[68:71]
ds_read_b64 v[96:97], v248 offset:3776
v_mfma_f32_16x16x32_bf16 v[72:75], v[116:119], v[164:167], v[72:75]
ds_read_b64 v[98:99], v248 offset:3784
s_waitcnt lgkmcnt(9)
v_mfma_f32_16x16x32_bf16 v[72:75], v[112:115], v[168:171], v[72:75]
ds_read_b128 v[128:131], v249 offset:192
v_mfma_f32_16x16x32_bf16 v[76:79], v[116:119], v[168:171], v[76:79]
ds_read_b64 v[100:101], v248 offset:3264
v_mfma_f32_16x16x32_bf16 v[72:75], v[120:123], v[160:163], v[72:75]
ds_read_b64 v[102:103], v248 offset:3272
v_mfma_f32_16x16x32_bf16 v[76:79], v[120:123], v[164:167], v[76:79]
ds_read_b128 v[132:135], v249 offset:704
v_mfma_f32_16x16x32_bf16 v[80:83], v[120:123], v[168:171], v[80:83]
ds_read_b64 v[104:105], v248 offset:2752
s_waitcnt lgkmcnt(11)
v_mfma_f32_16x16x32_bf16 v[76:79], v[112:115], v[172:175], v[76:79]
ds_read_b64 v[106:107], v248 offset:2760
v_mfma_f32_16x16x32_bf16 v[80:83], v[116:119], v[172:175], v[80:83]
ds_read_b128 v[136:139], v249 offset:1216
v_mfma_f32_16x16x32_bf16 v[84:87], v[120:123], v[172:175], v[84:87]
ds_read_b64 v[108:109], v248 offset:2240
v_mfma_f32_16x16x32_bf16 v[76:79], v[124:127], v[160:163], v[76:79]
ds_read_b64 v[110:111], v248 offset:2248
v_mfma_f32_16x16x32_bf16 v[80:83], v[124:127], v[164:167], v[80:83]
ds_read_b128 v[140:143], v249 offset:1728
v_mfma_f32_16x16x32_bf16 v[84:87], v[124:127], v[168:171], v[84:87]
ds_read_b128 v[144:147], v249 offset:2240
v_mfma_f32_16x16x32_bf16 v[88:91], v[124:127], v[172:175], v[88:91]
ds_read_b128 v[148:151], v249 offset:2752
s_waitcnt lgkmcnt(15)
v_mfma_f32_16x16x32_bf16 v[80:83], v[112:115], v[176:179], v[80:83]
ds_read_b128 v[152:155], v249 offset:3264
v_mfma_f32_16x16x32_bf16 v[84:87], v[116:119], v[176:179], v[84:87]
ds_read_b128 v[156:159], v249 offset:3776
v_mfma_f32_16x16x32_bf16 v[88:91], v[120:123], v[176:179], v[88:91]
v_mfma_f32_16x16x32_bf16 v[92:95], v[124:127], v[176:179], v[92:95]
v_mfma_f32_16x16x32_bf16 v[84:87], v[112:115], v[180:183], v[84:87]
v_mfma_f32_16x16x32_bf16 v[88:91], v[116:119], v[180:183], v[88:91]
v_mfma_f32_16x16x32_bf16 v[92:95], v[120:123], v[180:183], v[92:95]
v_mfma_f32_16x16x32_bf16 v[88:91], v[112:115], v[184:187], v[88:91]
v_mfma_f32_16x16x32_bf16 v[92:95], v[116:119], v[184:187], v[92:95]
s_waitcnt lgkmcnt(15)
v_mfma_f32_16x16x32_bf16 v[92:95], v[112:115], v[188:191], v[92:95]
s_waitcnt lgkmcnt(13)
v_mfma_f32_16x16x32_bf16 v[64:67], v[96:99], v[128:131], v[64:67]
s_waitcnt lgkmcnt(10)
v_mfma_f32_16x16x32_bf16 v[68:71], v[96:99], v[132:135], v[68:71]
v_mfma_f32_16x16x32_bf16 v[68:71], v[100:103], v[128:131], v[68:71]
ds_read_b64 v[112:113], v248 offset:3712
v_mfma_f32_16x16x32_bf16 v[72:75], v[100:103], v[132:135], v[72:75]
ds_read_b64 v[114:115], v248 offset:3720
s_waitcnt lgkmcnt(9)
v_mfma_f32_16x16x32_bf16 v[72:75], v[96:99], v[136:139], v[72:75]
ds_read_b128 v[160:163], v249 offset:128
v_mfma_f32_16x16x32_bf16 v[76:79], v[100:103], v[136:139], v[76:79]
ds_read_b64 v[116:117], v248 offset:3200
v_mfma_f32_16x16x32_bf16 v[72:75], v[104:107], v[128:131], v[72:75]
ds_read_b64 v[118:119], v248 offset:3208
v_mfma_f32_16x16x32_bf16 v[76:79], v[104:107], v[132:135], v[76:79]
ds_read_b128 v[164:167], v249 offset:640
v_mfma_f32_16x16x32_bf16 v[80:83], v[104:107], v[136:139], v[80:83]
ds_read_b64 v[120:121], v248 offset:2688
s_waitcnt lgkmcnt(11)
v_mfma_f32_16x16x32_bf16 v[76:79], v[96:99], v[140:143], v[76:79]
ds_read_b64 v[122:123], v248 offset:2696
v_mfma_f32_16x16x32_bf16 v[80:83], v[100:103], v[140:143], v[80:83]
ds_read_b128 v[168:171], v249 offset:1152
v_mfma_f32_16x16x32_bf16 v[84:87], v[104:107], v[140:143], v[84:87]
ds_read_b64 v[124:125], v248 offset:2176
v_mfma_f32_16x16x32_bf16 v[76:79], v[108:111], v[128:131], v[76:79]
ds_read_b64 v[126:127], v248 offset:2184
v_mfma_f32_16x16x32_bf16 v[80:83], v[108:111], v[132:135], v[80:83]
ds_read_b128 v[172:175], v249 offset:1664
v_mfma_f32_16x16x32_bf16 v[84:87], v[108:111], v[136:139], v[84:87]
ds_read_b128 v[176:179], v249 offset:2176
v_mfma_f32_16x16x32_bf16 v[88:91], v[108:111], v[140:143], v[88:91]
ds_read_b128 v[180:183], v249 offset:2688
s_waitcnt lgkmcnt(15)
v_mfma_f32_16x16x32_bf16 v[80:83], v[96:99], v[144:147], v[80:83]
ds_read_b128 v[184:187], v249 offset:3200
v_mfma_f32_16x16x32_bf16 v[84:87], v[100:103], v[144:147], v[84:87]
ds_read_b128 v[188:191], v249 offset:3712
v_mfma_f32_16x16x32_bf16 v[88:91], v[104:107], v[144:147], v[88:91]
v_mfma_f32_16x16x32_bf16 v[92:95], v[108:111], v[144:147], v[92:95]
v_mfma_f32_16x16x32_bf16 v[84:87], v[96:99], v[148:151], v[84:87]
v_mfma_f32_16x16x32_bf16 v[88:91], v[100:103], v[148:151], v[88:91]
v_mfma_f32_16x16x32_bf16 v[92:95], v[104:107], v[148:151], v[92:95]
v_mfma_f32_16x16x32_bf16 v[88:91], v[96:99], v[152:155], v[88:91]
v_mfma_f32_16x16x32_bf16 v[92:95], v[100:103], v[152:155], v[92:95]
s_waitcnt lgkmcnt(15)
v_mfma_f32_16x16x32_bf16 v[92:95], v[96:99], v[156:159], v[92:95]
s_waitcnt lgkmcnt(13)
v_mfma_f32_16x16x32_bf16 v[64:67], v[112:115], v[160:163], v[64:67]
s_waitcnt lgkmcnt(10)
v_mfma_f32_16x16x32_bf16 v[68:71], v[112:115], v[164:167], v[68:71]
v_mfma_f32_16x16x32_bf16 v[68:71], v[116:119], v[160:163], v[68:71]
ds_read_b64 v[96:97], v248 offset:3648
v_mfma_f32_16x16x32_bf16 v[72:75], v[116:119], v[164:167], v[72:75]
ds_read_b64 v[98:99], v248 offset:3656
s_waitcnt lgkmcnt(9)
v_mfma_f32_16x16x32_bf16 v[72:75], v[112:115], v[168:171], v[72:75]
ds_read_b128 v[128:131], v249 offset:64
v_mfma_f32_16x16x32_bf16 v[76:79], v[116:119], v[168:171], v[76:79]
ds_read_b64 v[100:101], v248 offset:3136
v_mfma_f32_16x16x32_bf16 v[72:75], v[120:123], v[160:163], v[72:75]
ds_read_b64 v[102:103], v248 offset:3144
v_mfma_f32_16x16x32_bf16 v[76:79], v[120:123], v[164:167], v[76:79]
ds_read_b128 v[132:135], v249 offset:576
v_mfma_f32_16x16x32_bf16 v[80:83], v[120:123], v[168:171], v[80:83]
ds_read_b64 v[104:105], v248 offset:2624
s_waitcnt lgkmcnt(11)
v_mfma_f32_16x16x32_bf16 v[76:79], v[112:115], v[172:175], v[76:79]
ds_read_b64 v[106:107], v248 offset:2632
v_mfma_f32_16x16x32_bf16 v[80:83], v[116:119], v[172:175], v[80:83]
ds_read_b128 v[136:139], v249 offset:1088
v_mfma_f32_16x16x32_bf16 v[84:87], v[120:123], v[172:175], v[84:87]
ds_read_b64 v[108:109], v248 offset:2112
v_mfma_f32_16x16x32_bf16 v[76:79], v[124:127], v[160:163], v[76:79]
ds_read_b64 v[110:111], v248 offset:2120
v_mfma_f32_16x16x32_bf16 v[80:83], v[124:127], v[164:167], v[80:83]
ds_read_b128 v[140:143], v249 offset:1600
v_mfma_f32_16x16x32_bf16 v[84:87], v[124:127], v[168:171], v[84:87]
ds_read_b128 v[144:147], v249 offset:2112
v_mfma_f32_16x16x32_bf16 v[88:91], v[124:127], v[172:175], v[88:91]
ds_read_b128 v[148:151], v249 offset:2624
s_waitcnt lgkmcnt(15)
v_mfma_f32_16x16x32_bf16 v[80:83], v[112:115], v[176:179], v[80:83]
ds_read_b128 v[152:155], v249 offset:3136
v_mfma_f32_16x16x32_bf16 v[84:87], v[116:119], v[176:179], v[84:87]
ds_read_b128 v[156:159], v249 offset:3648
v_mfma_f32_16x16x32_bf16 v[88:91], v[120:123], v[176:179], v[88:91]
v_mfma_f32_16x16x32_bf16 v[92:95], v[124:127], v[176:179], v[92:95]
v_mfma_f32_16x16x32_bf16 v[84:87], v[112:115], v[180:183], v[84:87]
v_mfma_f32_16x16x32_bf16 v[88:91], v[116:119], v[180:183], v[88:91]
v_mfma_f32_16x16x32_bf16 v[92:95], v[120:123], v[180:183], v[92:95]
v_mfma_f32_16x16x32_bf16 v[88:91], v[112:115], v[184:187], v[88:91]
v_mfma_f32_16x16x32_bf16 v[92:95], v[116:119], v[184:187], v[92:95]
s_waitcnt lgkmcnt(15)
v_mfma_f32_16x16x32_bf16 v[92:95], v[112:115], v[188:191], v[92:95]
s_waitcnt lgkmcnt(13)
v_mfma_f32_16x16x32_bf16 v[64:67], v[96:99], v[128:131], v[64:67]
s_waitcnt lgkmcnt(10)
v_mfma_f32_16x16x32_bf16 v[68:71], v[96:99], v[132:135], v[68:71]
v_mfma_f32_16x16x32_bf16 v[68:71], v[100:103], v[128:131], v[68:71]
ds_read_b64 v[112:113], v248 offset:3584
v_mfma_f32_16x16x32_bf16 v[72:75], v[100:103], v[132:135], v[72:75]
ds_read_b64 v[114:115], v248 offset:3592
s_waitcnt lgkmcnt(9)
v_mfma_f32_16x16x32_bf16 v[72:75], v[96:99], v[136:139], v[72:75]
ds_read_b128 v[160:163], v249 offset:0
v_mfma_f32_16x16x32_bf16 v[76:79], v[100:103], v[136:139], v[76:79]
ds_read_b64 v[116:117], v248 offset:3072
v_mfma_f32_16x16x32_bf16 v[72:75], v[104:107], v[128:131], v[72:75]
ds_read_b64 v[118:119], v248 offset:3080
v_mfma_f32_16x16x32_bf16 v[76:79], v[104:107], v[132:135], v[76:79]
ds_read_b128 v[164:167], v249 offset:512
v_mfma_f32_16x16x32_bf16 v[80:83], v[104:107], v[136:139], v[80:83]
ds_read_b64 v[120:121], v248 offset:2560
s_waitcnt lgkmcnt(11)
v_mfma_f32_16x16x32_bf16 v[76:79], v[96:99], v[140:143], v[76:79]
ds_read_b64 v[122:123], v248 offset:2568
v_mfma_f32_16x16x32_bf16 v[80:83], v[100:103], v[140:143], v[80:83]
ds_read_b128 v[168:171], v249 offset:1024
v_mfma_f32_16x16x32_bf16 v[84:87], v[104:107], v[140:143], v[84:87]
ds_read_b64 v[124:125], v248 offset:2048
v_mfma_f32_16x16x32_bf16 v[76:79], v[108:111], v[128:131], v[76:79]
ds_read_b64 v[126:127], v248 offset:2056
v_mfma_f32_16x16x32_bf16 v[80:83], v[108:111], v[132:135], v[80:83]
ds_read_b128 v[172:175], v249 offset:1536
v_mfma_f32_16x16x32_bf16 v[84:87], v[108:111], v[136:139], v[84:87]
ds_read_b128 v[176:179], v249 offset:2048
v_mfma_f32_16x16x32_bf16 v[88:91], v[108:111], v[140:143], v[88:91]
ds_read_b128 v[180:183], v249 offset:2560
s_waitcnt lgkmcnt(15)
v_mfma_f32_16x16x32_bf16 v[80:83], v[96:99], v[144:147], v[80:83]
ds_read_b128 v[184:187], v249 offset:3072
v_mfma_f32_16x16x32_bf16 v[84:87], v[100:103], v[144:147], v[84:87]
ds_read_b128 v[188:191], v249 offset:3584
v_mfma_f32_16x16x32_bf16 v[88:91], v[104:107], v[144:147], v[88:91]
v_mfma_f32_16x16x32_bf16 v[92:95], v[108:111], v[144:147], v[92:95]
v_mfma_f32_16x16x32_bf16 v[84:87], v[96:99], v[148:151], v[84:87]
v_mfma_f32_16x16x32_bf16 v[88:91], v[100:103], v[148:151], v[88:91]
v_mfma_f32_16x16x32_bf16 v[92:95], v[104:107], v[148:151], v[92:95]
v_mfma_f32_16x16x32_bf16 v[88:91], v[96:99], v[152:155], v[88:91]
v_mfma_f32_16x16x32_bf16 v[92:95], v[100:103], v[152:155], v[92:95]
s_waitcnt lgkmcnt(15)
v_mfma_f32_16x16x32_bf16 v[92:95], v[96:99], v[156:159], v[92:95]
s_waitcnt lgkmcnt(13)
v_mfma_f32_16x16x32_bf16 v[64:67], v[112:115], v[160:163], v[64:67]
s_waitcnt lgkmcnt(10)
v_mfma_f32_16x16x32_bf16 v[68:71], v[112:115], v[164:167], v[68:71]
v_mfma_f32_16x16x32_bf16 v[68:71], v[116:119], v[160:163], v[68:71]
v_mfma_f32_16x16x32_bf16 v[72:75], v[116:119], v[164:167], v[72:75]
s_waitcnt lgkmcnt(7)
v_mfma_f32_16x16x32_bf16 v[72:75], v[112:115], v[168:171], v[72:75]
v_mfma_f32_16x16x32_bf16 v[76:79], v[116:119], v[168:171], v[76:79]
v_mfma_f32_16x16x32_bf16 v[72:75], v[120:123], v[160:163], v[72:75]
v_mfma_f32_16x16x32_bf16 v[76:79], v[120:123], v[164:167], v[76:79]
v_mfma_f32_16x16x32_bf16 v[80:83], v[120:123], v[168:171], v[80:83]
s_waitcnt lgkmcnt(4)
v_mfma_f32_16x16x32_bf16 v[76:79], v[112:115], v[172:175], v[76:79]
v_mfma_f32_16x16x32_bf16 v[80:83], v[116:119], v[172:175], v[80:83]
v_mfma_f32_16x16x32_bf16 v[84:87], v[120:123], v[172:175], v[84:87]
v_mfma_f32_16x16x32_bf16 v[76:79], v[124:127], v[160:163], v[76:79]
v_mfma_f32_16x16x32_bf16 v[80:83], v[124:127], v[164:167], v[80:83]
v_mfma_f32_16x16x32_bf16 v[84:87], v[124:127], v[168:171], v[84:87]
v_mfma_f32_16x16x32_bf16 v[88:91], v[124:127], v[172:175], v[88:91]
s_waitcnt lgkmcnt(3)
v_mfma_f32_16x16x32_bf16 v[80:83], v[112:115], v[176:179], v[80:83]
v_mfma_f32_16x16x32_bf16 v[84:87], v[116:119], v[176:179], v[84:87]
v_mfma_f32_16x16x32_bf16 v[88:91], v[120:123], v[176:179], v[88:91]
v_mfma_f32_16x16x32_bf16 v[92:95], v[124:127], v[176:179], v[92:95]
s_waitcnt lgkmcnt(2)
v_mfma_f32_16x16x32_bf16 v[84:87], v[112:115], v[180:183], v[84:87]
v_mfma_f32_16x16x32_bf16 v[88:91], v[116:119], v[180:183], v[88:91]
v_mfma_f32_16x16x32_bf16 v[92:95], v[120:123], v[180:183], v[92:95]
s_waitcnt lgkmcnt(1)
v_mfma_f32_16x16x32_bf16 v[88:91], v[112:115], v[184:187], v[88:91]
v_mfma_f32_16x16x32_bf16 v[92:95], v[116:119], v[184:187], v[92:95]
s_waitcnt lgkmcnt(0)
v_mfma_f32_16x16x32_bf16 v[92:95], v[112:115], v[188:191], v[92:95]
s_lshl_b32 s6, s65, 12
s_add_u32 s6, s6, 2162688
v_lshlrev_b32 v16, 5, v14
v_lshlrev_b32 v18, 3, v15
v_add_u32 v16, v16, v18
v_cvt_pk_bf16_f32 v192, v64, v65
v_cvt_pk_bf16_f32 v193, v66, v67
buffer_store_dwordx2 v[192:193], v16, s[16:19], s6 offen offset:0 sc1
v_cvt_pk_bf16_f32 v194, v68, v69
v_cvt_pk_bf16_f32 v195, v70, v71
buffer_store_dwordx2 v[194:195], v16, s[16:19], s6 offen offset:512 sc1
v_cvt_pk_bf16_f32 v196, v72, v73
v_cvt_pk_bf16_f32 v197, v74, v75
buffer_store_dwordx2 v[196:197], v16, s[16:19], s6 offen offset:1024 sc1
v_cvt_pk_bf16_f32 v198, v76, v77
v_cvt_pk_bf16_f32 v199, v78, v79
buffer_store_dwordx2 v[198:199], v16, s[16:19], s6 offen offset:1536 sc1
s_barrier
ds_read_b64 v[96:97], v248 offset:1984
ds_read_b64 v[98:99], v248 offset:1992
ds_read_b128 v[128:131], v249 offset:448
ds_read_b64 v[100:101], v248 offset:1472
ds_read_b64 v[102:103], v248 offset:1480
ds_read_b128 v[132:135], v249 offset:960
ds_read_b64 v[104:105], v248 offset:960
ds_read_b64 v[106:107], v248 offset:968
ds_read_b128 v[136:139], v249 offset:1472
ds_read_b64 v[108:109], v248 offset:448
ds_read_b64 v[110:111], v248 offset:456
ds_read_b128 v[140:143], v249 offset:1984
s_waitcnt lgkmcnt(9)
v_mfma_f32_16x16x32_bf16 v[80:83], v[96:99], v[128:131], v[80:83]
ds_read_b64 v[112:113], v248 offset:1920
ds_read_b64 v[114:115], v248 offset:1928
s_waitcnt lgkmcnt(8)
v_mfma_f32_16x16x32_bf16 v[84:87], v[96:99], v[132:135], v[84:87]
ds_read_b128 v[160:163], v249 offset:384
ds_read_b64 v[116:117], v248 offset:1408
v_mfma_f32_16x16x32_bf16 v[84:87], v[100:103], v[128:131], v[84:87]
ds_read_b64 v[118:119], v248 offset:1416
ds_read_b128 v[164:167], v249 offset:896
v_mfma_f32_16x16x32_bf16 v[88:91], v[100:103], v[132:135], v[88:91]
ds_read_b64 v[120:121], v248 offset:896
ds_read_b64 v[122:123], v248 offset:904
s_waitcnt lgkmcnt(11)
v_mfma_f32_16x16x32_bf16 v[88:91], v[96:99], v[136:139], v[88:91]
ds_read_b128 v[168:171], v249 offset:1408
ds_read_b64 v[124:125], v248 offset:384
v_mfma_f32_16x16x32_bf16 v[92:95], v[100:103], v[136:139], v[92:95]
ds_read_b64 v[126:127], v248 offset:392
ds_read_b128 v[172:175], v249 offset:1920
v_mfma_f32_16x16x32_bf16 v[88:91], v[104:107], v[128:131], v[88:91]
v_mfma_f32_16x16x32_bf16 v[92:95], v[104:107], v[132:135], v[92:95]
s_waitcnt lgkmcnt(12)
v_mfma_f32_16x16x32_bf16 v[92:95], v[96:99], v[140:143], v[92:95]
v_mfma_f32_16x16x32_bf16 v[92:95], v[108:111], v[128:131], v[92:95]
s_waitcnt lgkmcnt(9)
v_mfma_f32_16x16x32_bf16 v[80:83], v[112:115], v[160:163], v[80:83]
ds_read_b64 v[96:97], v248 offset:1856
ds_read_b64 v[98:99], v248 offset:1864
s_waitcnt lgkmcnt(8)
v_mfma_f32_16x16x32_bf16 v[84:87], v[112:115], v[164:167], v[84:87]
ds_read_b128 v[128:131], v249 offset:320
ds_read_b64 v[100:101], v248 offset:1344
v_mfma_f32_16x16x32_bf16 v[84:87], v[116:119], v[160:163], v[84:87]
ds_read_b64 v[102:103], v248 offset:1352
ds_read_b128 v[132:135], v249 offset:832
v_mfma_f32_16x16x32_bf16 v[88:91], v[116:119], v[164:167], v[88:91]
ds_read_b64 v[104:105], v248 offset:832
ds_read_b64 v[106:107], v248 offset:840
s_waitcnt lgkmcnt(11)
v_mfma_f32_16x16x32_bf16 v[88:91], v[112:115], v[168:171], v[88:91]
ds_read_b128 v[136:139], v249 offset:1344
ds_read_b64 v[108:109], v248 offset:320
v_mfma_f32_16x16x32_bf16 v[92:95], v[116:119], v[168:171], v[92:95]
ds_read_b64 v[110:111], v248 offset:328
ds_read_b128 v[140:143], v249 offset:1856
v_mfma_f32_16x16x32_bf16 v[88:91], v[120:123], v[160:163], v[88:91]
v_mfma_f32_16x16x32_bf16 v[92:95], v[120:123], v[164:167], v[92:95]
s_waitcnt lgkmcnt(12)
v_mfma_f32_16x16x32_bf16 v[92:95], v[112:115], v[172:175], v[92:95]
v_mfma_f32_16x16x32_bf16 v[92:95], v[124:127], v[160:163], v[92:95]
s_waitcnt lgkmcnt(9)
v_mfma_f32_16x16x32_bf16 v[80:83], v[96:99], v[128:131], v[80:83]
ds_read_b64 v[112:113], v248 offset:1792
ds_read_b64 v[114:115], v248 offset:1800
s_waitcnt lgkmcnt(8)
v_mfma_f32_16x16x32_bf16 v[84:87], v[96:99], v[132:135], v[84:87]
ds_read_b128 v[160:163], v249 offset:256
ds_read_b64 v[116:117], v248 offset:1280
v_mfma_f32_16x16x32_bf16 v[84:87], v[100:103], v[128:131], v[84:87]
ds_read_b64 v[118:119], v248 offset:1288
ds_read_b128 v[164:167], v249 offset:768
v_mfma_f32_16x16x32_bf16 v[88:91], v[100:103], v[132:135], v[88:91]
ds_read_b64 v[120:121], v248 offset:768
ds_read_b64 v[122:123], v248 offset:776
s_waitcnt lgkmcnt(11)
v_mfma_f32_16x16x32_bf16 v[88:91], v[96:99], v[136:139], v[88:91]
ds_read_b128 v[168:171], v249 offset:1280
ds_read_b64 v[124:125], v248 offset:256
v_mfma_f32_16x16x32_bf16 v[92:95], v[100:103], v[136:139], v[92:95]
ds_read_b64 v[126:127], v248 offset:264
ds_read_b128 v[172:175], v249 offset:1792
v_mfma_f32_16x16x32_bf16 v[88:91], v[104:107], v[128:131], v[88:91]
v_mfma_f32_16x16x32_bf16 v[92:95], v[104:107], v[132:135], v[92:95]
s_waitcnt lgkmcnt(12)
v_mfma_f32_16x16x32_bf16 v[92:95], v[96:99], v[140:143], v[92:95]
v_mfma_f32_16x16x32_bf16 v[92:95], v[108:111], v[128:131], v[92:95]
s_waitcnt lgkmcnt(9)
v_mfma_f32_16x16x32_bf16 v[80:83], v[112:115], v[160:163], v[80:83]
ds_read_b64 v[96:97], v248 offset:1728
ds_read_b64 v[98:99], v248 offset:1736
s_waitcnt lgkmcnt(8)
v_mfma_f32_16x16x32_bf16 v[84:87], v[112:115], v[164:167], v[84:87]
ds_read_b128 v[128:131], v249 offset:192
ds_read_b64 v[100:101], v248 offset:1216
v_mfma_f32_16x16x32_bf16 v[84:87], v[116:119], v[160:163], v[84:87]
ds_read_b64 v[102:103], v248 offset:1224
ds_read_b128 v[132:135], v249 offset:704
v_mfma_f32_16x16x32_bf16 v[88:91], v[116:119], v[164:167], v[88:91]
ds_read_b64 v[104:105], v248 offset:704
ds_read_b64 v[106:107], v248 offset:712
s_waitcnt lgkmcnt(11)
v_mfma_f32_16x16x32_bf16 v[88:91], v[112:115], v[168:171], v[88:91]
ds_read_b128 v[136:139], v249 offset:1216
ds_read_b64 v[108:109], v248 offset:192
v_mfma_f32_16x16x32_bf16 v[92:95], v[116:119], v[168:171], v[92:95]
ds_read_b64 v[110:111], v248 offset:200
ds_read_b128 v[140:143], v249 offset:1728
v_mfma_f32_16x16x32_bf16 v[88:91], v[120:123], v[160:163], v[88:91]
v_mfma_f32_16x16x32_bf16 v[92:95], v[120:123], v[164:167], v[92:95]
s_waitcnt lgkmcnt(12)
v_mfma_f32_16x16x32_bf16 v[92:95], v[112:115], v[172:175], v[92:95]
v_mfma_f32_16x16x32_bf16 v[92:95], v[124:127], v[160:163], v[92:95]
s_waitcnt lgkmcnt(9)
v_mfma_f32_16x16x32_bf16 v[80:83], v[96:99], v[128:131], v[80:83]
ds_read_b64 v[112:113], v248 offset:1664
ds_read_b64 v[114:115], v248 offset:1672
s_waitcnt lgkmcnt(8)
v_mfma_f32_16x16x32_bf16 v[84:87], v[96:99], v[132:135], v[84:87]
ds_read_b128 v[160:163], v249 offset:128
ds_read_b64 v[116:117], v248 offset:1152
v_mfma_f32_16x16x32_bf16 v[84:87], v[100:103], v[128:131], v[84:87]
ds_read_b64 v[118:119], v248 offset:1160
ds_read_b128 v[164:167], v249 offset:640
v_mfma_f32_16x16x32_bf16 v[88:91], v[100:103], v[132:135], v[88:91]
ds_read_b64 v[120:121], v248 offset:640
ds_read_b64 v[122:123], v248 offset:648
s_waitcnt lgkmcnt(11)
v_mfma_f32_16x16x32_bf16 v[88:91], v[96:99], v[136:139], v[88:91]
ds_read_b128 v[168:171], v249 offset:1152
ds_read_b64 v[124:125], v248 offset:128
v_mfma_f32_16x16x32_bf16 v[92:95], v[100:103], v[136:139], v[92:95]
ds_read_b64 v[126:127], v248 offset:136
ds_read_b128 v[172:175], v249 offset:1664
v_mfma_f32_16x16x32_bf16 v[88:91], v[104:107], v[128:131], v[88:91]
v_mfma_f32_16x16x32_bf16 v[92:95], v[104:107], v[132:135], v[92:95]
s_waitcnt lgkmcnt(12)
v_mfma_f32_16x16x32_bf16 v[92:95], v[96:99], v[140:143], v[92:95]
v_mfma_f32_16x16x32_bf16 v[92:95], v[108:111], v[128:131], v[92:95]
s_waitcnt lgkmcnt(9)
v_mfma_f32_16x16x32_bf16 v[80:83], v[112:115], v[160:163], v[80:83]
ds_read_b64 v[96:97], v248 offset:1600
ds_read_b64 v[98:99], v248 offset:1608
s_waitcnt lgkmcnt(8)
v_mfma_f32_16x16x32_bf16 v[84:87], v[112:115], v[164:167], v[84:87]
ds_read_b128 v[128:131], v249 offset:64
ds_read_b64 v[100:101], v248 offset:1088
v_mfma_f32_16x16x32_bf16 v[84:87], v[116:119], v[160:163], v[84:87]
ds_read_b64 v[102:103], v248 offset:1096
ds_read_b128 v[132:135], v249 offset:576
v_mfma_f32_16x16x32_bf16 v[88:91], v[116:119], v[164:167], v[88:91]
ds_read_b64 v[104:105], v248 offset:576
ds_read_b64 v[106:107], v248 offset:584
s_waitcnt lgkmcnt(11)
v_mfma_f32_16x16x32_bf16 v[88:91], v[112:115], v[168:171], v[88:91]
ds_read_b128 v[136:139], v249 offset:1088
ds_read_b64 v[108:109], v248 offset:64
v_mfma_f32_16x16x32_bf16 v[92:95], v[116:119], v[168:171], v[92:95]
ds_read_b64 v[110:111], v248 offset:72
ds_read_b128 v[140:143], v249 offset:1600
v_mfma_f32_16x16x32_bf16 v[88:91], v[120:123], v[160:163], v[88:91]
v_mfma_f32_16x16x32_bf16 v[92:95], v[120:123], v[164:167], v[92:95]
s_waitcnt lgkmcnt(12)
v_mfma_f32_16x16x32_bf16 v[92:95], v[112:115], v[172:175], v[92:95]
v_mfma_f32_16x16x32_bf16 v[92:95], v[124:127], v[160:163], v[92:95]
s_waitcnt lgkmcnt(9)
v_mfma_f32_16x16x32_bf16 v[80:83], v[96:99], v[128:131], v[80:83]
ds_read_b64 v[112:113], v248 offset:1536
ds_read_b64 v[114:115], v248 offset:1544
s_waitcnt lgkmcnt(8)
v_mfma_f32_16x16x32_bf16 v[84:87], v[96:99], v[132:135], v[84:87]
ds_read_b128 v[160:163], v249 offset:0
ds_read_b64 v[116:117], v248 offset:1024
v_mfma_f32_16x16x32_bf16 v[84:87], v[100:103], v[128:131], v[84:87]
ds_read_b64 v[118:119], v248 offset:1032
ds_read_b128 v[164:167], v249 offset:512
v_mfma_f32_16x16x32_bf16 v[88:91], v[100:103], v[132:135], v[88:91]
ds_read_b64 v[120:121], v248 offset:512
ds_read_b64 v[122:123], v248 offset:520
s_waitcnt lgkmcnt(11)
v_mfma_f32_16x16x32_bf16 v[88:91], v[96:99], v[136:139], v[88:91]
ds_read_b128 v[168:171], v249 offset:1024
ds_read_b64 v[124:125], v248 offset:0
v_mfma_f32_16x16x32_bf16 v[92:95], v[100:103], v[136:139], v[92:95]
ds_read_b64 v[126:127], v248 offset:8
ds_read_b128 v[172:175], v249 offset:1536
v_mfma_f32_16x16x32_bf16 v[88:91], v[104:107], v[128:131], v[88:91]
v_mfma_f32_16x16x32_bf16 v[92:95], v[104:107], v[132:135], v[92:95]
s_waitcnt lgkmcnt(12)
v_mfma_f32_16x16x32_bf16 v[92:95], v[96:99], v[140:143], v[92:95]
v_mfma_f32_16x16x32_bf16 v[92:95], v[108:111], v[128:131], v[92:95]
s_waitcnt lgkmcnt(9)
v_mfma_f32_16x16x32_bf16 v[80:83], v[112:115], v[160:163], v[80:83]
s_waitcnt lgkmcnt(6)
v_mfma_f32_16x16x32_bf16 v[84:87], v[112:115], v[164:167], v[84:87]
v_mfma_f32_16x16x32_bf16 v[84:87], v[116:119], v[160:163], v[84:87]
v_mfma_f32_16x16x32_bf16 v[88:91], v[116:119], v[164:167], v[88:91]
s_waitcnt lgkmcnt(3)
v_mfma_f32_16x16x32_bf16 v[88:91], v[112:115], v[168:171], v[88:91]
v_mfma_f32_16x16x32_bf16 v[92:95], v[116:119], v[168:171], v[92:95]
v_mfma_f32_16x16x32_bf16 v[88:91], v[120:123], v[160:163], v[88:91]
v_mfma_f32_16x16x32_bf16 v[92:95], v[120:123], v[164:167], v[92:95]
s_waitcnt lgkmcnt(0)
v_mfma_f32_16x16x32_bf16 v[92:95], v[112:115], v[172:175], v[92:95]
v_mfma_f32_16x16x32_bf16 v[92:95], v[124:127], v[160:163], v[92:95]
v_cvt_pk_bf16_f32 v104, v80, v81
v_cvt_pk_bf16_f32 v105, v82, v83
buffer_store_dwordx2 v[104:105], v16, s[16:19], s6 offen offset:2048 sc1
v_cvt_pk_bf16_f32 v106, v84, v85
v_cvt_pk_bf16_f32 v107, v86, v87
buffer_store_dwordx2 v[106:107], v16, s[16:19], s6 offen offset:2560 sc1
v_cvt_pk_bf16_f32 v108, v88, v89
v_cvt_pk_bf16_f32 v109, v90, v91
buffer_store_dwordx2 v[108:109], v16, s[16:19], s6 offen offset:3072 sc1
v_cvt_pk_bf16_f32 v110, v92, v93
v_cvt_pk_bf16_f32 v111, v94, v95
buffer_store_dwordx2 v[110:111], v16, s[16:19], s6 offen offset:3584 sc1
s_branch LK_fin
LC_helper:
s_sub_u32 s65, s5, 4
s_waitcnt lgkmcnt(0)
s_mov_b32 s8, s32
s_mov_b32 s9, s33
s_mov_b32 s12, s52
s_mov_b32 s13, s53
s_mov_b32 s16, s62
s_mov_b32 s17, s63
s_mov_b32 s20, s56
s_mov_b32 s21, s57
s_mov_b32 s24, s54
s_mov_b32 s25, s55
s_mov_b32 s28, s58
s_mov_b32 s29, s59
s_cmp_lg_u32 s65, 0
s_cbranch_scc1 LC_nz
s_cmp_ge_u32 s64, 37
s_cbranch_scc1 LC_nz
v_mov_b32 v8, 0
v_mov_b32 v9, 0
v_mov_b32 v10, 0
v_mov_b32 v11, 0
s_cmp_ge_u32 s64, 34
s_cbranch_scc1 LC_nzb
v_lshlrev_b32 v2, 4, v1
s_lshl_b32 s6, s64, 10
buffer_store_dwordx4 v[8:11], v2, s[16:19], s6 offen sc0 sc1
s_branch LC_nzj
LC_nzb:
v_lshlrev_b32 v2, 7, v1
s_sub_u32 s6, s64, 34
s_lshl_b32 s6, s6, 13
s_add_u32 s6, s6, 4259840
buffer_store_dword v8, v2, s[16:19], s6 offen sc0 sc1
LC_nzj:
s_waitcnt vmcnt(0)
v_mov_b32 v2, 0
v_mov_b32 v3, 1
s_mov_b64 exec, 1
global_atomic_add v2, v3, s[60:61] sc1
s_mov_b64 exec, -1
LC_nz:
s_and_b32 s70, s4, 15
s_lshl_b32 s70, s70, 2
s_add_u32 s70, s70, s65
s_lshr_b32 s6, s3, 1
s_lshl_b32 s6, s6, 19
s_lshl_b32 s7, s70, 13
s_add_u32 s71, s6, s7
s_mul_i32 s6, s70, 3072
s_and_b32 s7, s3, 1
s_lshl_b32 s7, s7, 9
s_add_u32 s72, s6, s7
v_and_b32 v250, 7, v1
v_lshlrev_b32 v250, 10, v250
v_lshrrev_b32 v251, 3, v1
v_lshlrev_b32 v251, 7, v251
v_add_u32 v250, v250, v251
v_lshrrev_b32 v251, 4, v1
v_mul_u32_u24 v251, 196608, v251
v_bfe_u32 v252, v1, 2, 2
v_lshlrev_b32 v253, 10, v252
v_add_u32 v251, v251, v253
v_and_b32 v253, 3, v1
v_lshlrev_b32 v253, 7, v253
v_add_u32 v251, v251, v253
v_cmp_gt_u32 vcc, 3, v252
v_mov_b32 v253, 0x7ffffff0
s_nop 0
v_cndmask_b32 v251, v253, v251, vcc
s_add_u32 s6, s71, 128
s_mov_b32 exec_lo, 0xff
s_mov_b32 exec_hi, 0x0
buffer_load_dword v255, v250, s[8:11], s6 offen
s_add_u32 s6, s72, 196608
s_mov_b32 exec_lo, 0xffff
s_mov_b32 exec_hi, 0x0
buffer_load_dword v255, v251, s[12:15], s6 offen
s_mov_b64 exec, -1
s_lshl_b32 s66, s65, 18
s_lshl_b32 s6, s64, 3
s_add_u32 s66, s66, s6
v_lshlrev_b32 v2, 12, v1
s_add_u32 s67, s66, 0
s_mov_b64 exec, 1
s_add_u32 s6, s67, 4294964224
v_mov_b32 v3, s6
buffer_load_dwordx2 v[32:33], v3, s[8:11], 0 offen
s_add_u32 s6, s67, 4294965248
v_mov_b32 v3, s6
buffer_load_dwordx2 v[34:35], v3, s[8:11], 0 offen
s_add_u32 s6, s67, 4294966272
v_mov_b32 v3, s6
buffer_load_dwordx2 v[36:37], v3, s[8:11], 0 offen
s_mov_b64 exec, -1
buffer_load_dwordx2 v[38:39], v2, s[8:11], s67 offen offset:0
s_add_u32 s6, s71, 256
s_mov_b32 exec_lo, 0xffff
s_mov_b32 exec_hi, 0x0
buffer_load_dword v255, v250, s[8:11], s6 offen
s_add_u32 s6, s72, 393216
s_mov_b32 exec_lo, 0xffffffff
s_mov_b32 exec_hi, 0x0
buffer_load_dword v255, v251, s[12:15], s6 offen
s_mov_b64 exec, -1
buffer_load_dwordx2 v[40:41], v2, s[8:11], s67 offen offset:1024
buffer_load_dwordx2 v[42:43], v2, s[8:11], s67 offen offset:2048
s_add_u32 s6, s71, 512
s_mov_b32 exec_lo, 0xffff
s_mov_b32 exec_hi, 0x0
buffer_load_dword v255, v250, s[8:11], s6 offen
s_add_u32 s6, s72, 786432
s_mov_b32 exec_lo, 0xffffffff
s_mov_b32 exec_hi, 0x0
buffer_load_dword v255, v251, s[12:15], s6 offen
s_mov_b64 exec, -1
buffer_load_dwordx2 v[44:45], v2, s[8:11], s67 offen offset:3072
v_lshrrev_b32 v4, 1, v1
v_mul_u32_u24 v4, 4160, v4
v_and_b32 v5, 1, v1
v_lshlrev_b32 v5, 4, v5
v_add_u32 v4, v4, v5
v_add_u32 v4, 100352, v4
v_mov_b32 v8, 0
v_mov_b32 v9, 0
v_mov_b32 v10, 0
v_mov_b32 v11, 0
s_cmp_lg_u32 s65, 0
s_cbranch_scc1 LC_nopad
s_mov_b64 exec, 0xffffffff
ds_write_b128 v4, v[8:11]
s_mov_b64 exec, -1
LC_nopad:
s_lshl_b32 s6, s65, 9
s_sub_u32 s6, 100344, s6
v_lshlrev_b32 v5, 3, v1
v_sub_u32 v5, s6, v5
s_mov_b32 s68, 0x05040100
s_mov_b32 s69, 0x07060302
s_waitcnt vmcnt(0)
s_add_u32 s6, s71, 768
s_mov_b32 exec_lo, 0xffff
s_mov_b32 exec_hi, 0x0
buffer_load_dword v255, v250, s[8:11], s6 offen
s_add_u32 s6, s72, 1179648
s_mov_b32 exec_lo, 0xffffffff
s_mov_b32 exec_hi, 0x0
buffer_load_dword v255, v251, s[12:15], s6 offen
s_mov_b64 exec, -1
v_mov_b32_dpp v32, v40 wave_shr:1 row_mask:0xf bank_mask:0xf
v_mov_b32_dpp v33, v41 wave_shr:1 row_mask:0xf bank_mask:0xf
v_mov_b32_dpp v34, v42 wave_shr:1 row_mask:0xf bank_mask:0xf
v_mov_b32_dpp v35, v43 wave_shr:1 row_mask:0xf bank_mask:0xf
v_mov_b32_dpp v36, v44 wave_shr:1 row_mask:0xf bank_mask:0xf
v_mov_b32_dpp v37, v45 wave_shr:1 row_mask:0xf bank_mask:0xf
v_perm_b32 v64, v42, v44, s68
v_perm_b32 v65, v38, v40, s68
ds_write_b64 v5, v[64:65] offset:0
v_perm_b32 v66, v40, v42, s68
v_perm_b32 v67, v36, v38, s68
ds_write_b64 v5, v[66:67] offset:4160
v_perm_b32 v68, v38, v40, s68
v_perm_b32 v69, v34, v36, s68
ds_write_b64 v5, v[68:69] offset:8320
v_perm_b32 v70, v36, v38, s68
v_perm_b32 v71, v32, v34, s68
ds_write_b64 v5, v[70:71] offset:12480
v_perm_b32 v72, v42, v44, s69
v_perm_b32 v73, v38, v40, s69
ds_write_b64 v5, v[72:73] offset:16640
v_perm_b32 v74, v40, v42, s69
v_perm_b32 v75, v36, v38, s69
ds_write_b64 v5, v[74:75] offset:20800
v_perm_b32 v76, v38, v40, s69
v_perm_b32 v77, v34, v36, s69
ds_write_b64 v5, v[76:77] offset:24960
v_perm_b32 v78, v36, v38, s69
v_perm_b32 v79, v32, v34, s69
ds_write_b64 v5, v[78:79] offset:29120
v_perm_b32 v64, v43, v45, s68
v_perm_b32 v65, v39, v41, s68
ds_write_b64 v5, v[64:65] offset:33280
v_perm_b32 v66, v41, v43, s68
v_perm_b32 v67, v37, v39, s68
ds_write_b64 v5, v[66:67] offset:37440
v_perm_b32 v68, v39, v41, s68
v_perm_b32 v69, v35, v37, s68
ds_write_b64 v5, v[68:69] offset:41600
v_perm_b32 v70, v37, v39, s68
v_perm_b32 v71, v33, v35, s68
ds_write_b64 v5, v[70:71] offset:45760
v_perm_b32 v72, v43, v45, s69
v_perm_b32 v73, v39, v41, s69
ds_write_b64 v5, v[72:73] offset:49920
v_perm_b32 v74, v41, v43, s69
v_perm_b32 v75, v37, v39, s69
ds_write_b64 v5, v[74:75] offset:54080
v_perm_b32 v76, v39, v41, s69
v_perm_b32 v77, v35, v37, s69
ds_write_b64 v5, v[76:77] offset:58240
v_perm_b32 v78, v37, v39, s69
v_perm_b32 v79, v33, v35, s69
ds_write_b64 v5, v[78:79] offset:62400
s_waitcnt lgkmcnt(0)
s_barrier
s_add_u32 s67, s66, 1048576
s_mov_b64 exec, 1
s_add_u32 s6, s67, 4294964224
v_mov_b32 v3, s6
buffer_load_dwordx2 v[48:49], v3, s[8:11], 0 offen
s_add_u32 s6, s67, 4294965248
v_mov_b32 v3, s6
buffer_load_dwordx2 v[50:51], v3, s[8:11], 0 offen
s_add_u32 s6, s67, 4294966272
v_mov_b32 v3, s6
buffer_load_dwordx2 v[52:53], v3, s[8:11], 0 offen
s_mov_b64 exec, -1
buffer_load_dwordx2 v[54:55], v2, s[8:11], s67 offen offset:0
buffer_load_dwordx2 v[56:57], v2, s[8:11], s67 offen offset:1024
buffer_load_dwordx2 v[58:59], v2, s[8:11], s67 offen offset:2048
buffer_load_dwordx2 v[60:61], v2, s[8:11], s67 offen offset:3072
s_lshl_b32 s6, s4, 14
s_lshl_b32 s7, s65, 12
s_add_u32 s6, s6, s7
v_lshlrev_b32 v254, 7, v1
s_mov_b64 exec, 0xffffffff
buffer_load_dword v255, v254, s[24:27], s6 offen
s_mov_b64 exec, -1
v_subrev_u32 v5, 2048, v5
s_waitcnt vmcnt(1)
v_mov_b32_dpp v48, v56 wave_shr:1 row_mask:0xf bank_mask:0xf
v_mov_b32_dpp v49, v57 wave_shr:1 row_mask:0xf bank_mask:0xf
v_mov_b32_dpp v50, v58 wave_shr:1 row_mask:0xf bank_mask:0xf
v_mov_b32_dpp v51, v59 wave_shr:1 row_mask:0xf bank_mask:0xf
v_mov_b32_dpp v52, v60 wave_shr:1 row_mask:0xf bank_mask:0xf
v_mov_b32_dpp v53, v61 wave_shr:1 row_mask:0xf bank_mask:0xf
v_perm_b32 v64, v58, v60, s68
v_perm_b32 v65, v54, v56, s68
ds_write_b64 v5, v[64:65] offset:0
v_perm_b32 v66, v56, v58, s68
v_perm_b32 v67, v52, v54, s68
ds_write_b64 v5, v[66:67] offset:4160
v_perm_b32 v68, v54, v56, s68
v_perm_b32 v69, v50, v52, s68
ds_write_b64 v5, v[68:69] offset:8320
v_perm_b32 v70, v52, v54, s68
v_perm_b32 v71, v48, v50, s68
ds_write_b64 v5, v[70:71] offset:12480
v_perm_b32 v72, v58, v60, s69
v_perm_b32 v73, v54, v56, s69
ds_write_b64 v5, v[72:73] offset:16640
v_perm_b32 v74, v56, v58, s69
v_perm_b32 v75, v52, v54, s69
ds_write_b64 v5, v[74:75] offset:20800
v_perm_b32 v76, v54, v56, s69
v_perm_b32 v77, v50, v52, s69
ds_write_b64 v5, v[76:77] offset:24960
v_perm_b32 v78, v52, v54, s69
v_perm_b32 v79, v48, v50, s69
ds_write_b64 v5, v[78:79] offset:29120
v_perm_b32 v64, v59, v61, s68
v_perm_b32 v65, v55, v57, s68
ds_write_b64 v5, v[64:65] offset:33280
v_perm_b32 v66, v57, v59, s68
v_perm_b32 v67, v53, v55, s68
ds_write_b64 v5, v[66:67] offset:37440
v_perm_b32 v68, v55, v57, s68
v_perm_b32 v69, v51, v53, s68
ds_write_b64 v5, v[68:69] offset:41600
v_perm_b32 v70, v53, v55, s68
v_perm_b32 v71, v49, v51, s68
ds_write_b64 v5, v[70:71] offset:45760
v_perm_b32 v72, v59, v61, s69
v_perm_b32 v73, v55, v57, s69
ds_write_b64 v5, v[72:73] offset:49920
v_perm_b32 v74, v57, v59, s69
v_perm_b32 v75, v53, v55, s69
ds_write_b64 v5, v[74:75] offset:54080
v_perm_b32 v76, v55, v57, s69
v_perm_b32 v77, v51, v53, s69
ds_write_b64 v5, v[76:77] offset:58240
v_perm_b32 v78, v53, v55, s69
v_perm_b32 v79, v49, v51, s69
ds_write_b64 v5, v[78:79] offset:62400
s_waitcnt lgkmcnt(0)
s_barrier
v_lshrrev_b32 v18, 3, v1
v_lshlrev_b32 v18, 10, v18
v_and_b32 v19, 7, v1
v_bfe_u32 v17, v1, 4, 1
v_lshlrev_b32 v17, 2, v17
v_xor_b32 v19, v19, v17
v_lshlrev_b32 v19, 4, v19
v_add_u32 v18, v18, v19
s_and_b32 s7, s4, 7
s_lshl_b32 s7, s7, 7
s_lshl_b32 s6, s65, 13
s_add_u32 s7, s7, s6
s_lshl_b32 s79, s65, 10
s_add_u32 s6, s7, 0
s_add_u32 m0, s79, 0
s_nop 0
buffer_load_dwordx4 v18, s[24:27], s6 offen lds
s_add_u32 s6, s7, 32768
s_add_u32 m0, s79, 4096
s_nop 0
buffer_load_dwordx4 v18, s[24:27], s6 offen lds
s_add_u32 s6, s7, 65536
s_add_u32 m0, s79, 8192
s_nop 0
buffer_load_dwordx4 v18, s[24:27], s6 offen lds
s_add_u32 s6, s7, 98304
s_add_u32 m0, s79, 12288
s_nop 0
buffer_load_dwordx4 v18, s[24:27], s6 offen lds
s_add_u32 s6, s7, 131072
s_add_u32 m0, s79, 16384
s_nop 0
buffer_load_dwordx4 v18, s[24:27], s6 offen lds
s_add_u32 s6, s7, 163840
s_add_u32 m0, s79, 20480
s_nop 0
buffer_load_dwordx4 v18, s[24:27], s6 offen lds
s_add_u32 s6, s7, 196608
s_add_u32 m0, s79, 24576
s_nop 0
buffer_load_dwordx4 v18, s[24:27], s6 offen lds
s_add_u32 s6, s7, 229376
s_add_u32 m0, s79, 28672
s_nop 0
buffer_load_dwordx4 v18, s[24:27], s6 offen lds
s_add_u32 s6, s7, 262144
s_add_u32 m0, s79, 32768
s_nop 0
buffer_load_dwordx4 v18, s[24:27], s6 offen lds
s_add_u32 s6, s7, 294912
s_add_u32 m0, s79, 36864
s_nop 0
buffer_load_dwordx4 v18, s[24:27], s6 offen lds
s_add_u32 s6, s7, 327680
s_add_u32 m0, s79, 40960
s_nop 0
buffer_load_dwordx4 v18, s[24:27], s6 offen lds
s_add_u32 s6, s7, 360448
s_add_u32 m0, s79, 45056
s_nop 0
buffer_load_dwordx4 v18, s[24:27], s6 offen lds
s_add_u32 s6, s7, 393216
s_add_u32 m0, s79, 49152
s_nop 0
buffer_load_dwordx4 v18, s[24:27], s6 offen lds
s_add_u32 s6, s7, 425984
s_add_u32 m0, s79, 53248
s_nop 0
buffer_load_dwordx4 v18, s[24:27], s6 offen lds
s_add_u32 s6, s7, 458752
s_add_u32 m0, s79, 57344
s_nop 0
buffer_load_dwordx4 v18, s[24:27], s6 offen lds
s_add_u32 s6, s7, 491520
s_add_u32 m0, s79, 61440
s_nop 0
buffer_load_dwordx4 v18, s[24:27], s6 offen lds
s_branch LK_fin
LK_fin:
s_mov_b64 exec, -1
v_mov_b32 v2, 0
global_load_dword v2, v2, s[60:61] sc1
s_waitcnt vmcnt(0)
LK_fin_nw:
s_setprio 0
s_mov_b64 exec, -1
s_waitcnt lgkmcnt(0)
s_barrier
s_lshl_b32 s64, s3, 2
s_lshr_b32 s6, s4, 3
s_add_u32 s64, s64, s6
s_and_b32 s65, s4, 7
s_cmp_ge_u32 s5, 4
s_cbranch_scc1 LF_aux
s_cmp_lg_u32 s5, 0
s_cbranch_scc1 LF_na
v_readfirstlane_b32 s6, v2
s_nop 1
s_cmp_ge_u32 s6, 37
s_cbranch_scc1 LK_zok
LK_zp:
v_mov_b32 v2, 0
global_load_dword v2, v2, s[60:61] sc1
s_waitcnt vmcnt(0)
v_readfirstlane_b32 s6, v2
s_nop 1
s_cmp_ge_u32 s6, 37
s_cbranch_scc0 LK_zp
LK_zok:
s_cmp_ge_u32 s4, 16
s_cbranch_scc1 LK_ac
s_lshr_b32 s6, s3, 1
s_lshl_b32 s6, s6, 2
s_lshr_b32 s7, s4, 2
s_add_u32 s6, s6, s7
s_lshl_b32 s6, s6, 8
s_add_u32 s6, s6, 4259840
s_mov_b64 exec, 3
s_branch LK_aj
LK_ac:
s_lshl_b32 s6, s3, 9
s_add_u32 s6, s6, 4263936
s_mov_b64 exec, 15
LK_aj:
v_lshlrev_b32 v2, 7, v1
v_mov_b32 v3, 1
buffer_atomic_add v3, v2, s[16:19], s6 offen sc1
s_mov_b64 exec, -1
LF_na:
s_and_b32 s66, s5, 1
s_lshr_b32 s67, s5, 1
v_lshlrev_b32 v20, 4, v1
s_lshl_b32 s68, s64, 1
s_add_u32 s68, s68, s66
s_lshl_b32 s68, s68, 15
s_lshl_b32 s6, s67, 14
s_add_u32 s68, s68, s6
s_add_u32 s68, s68, 65536
v_and_b32 v22, 31, v1
v_lshlrev_b32 v22, 2, v22
s_lshl_b32 s6, s64, 8
s_lshl_b32 s7, s66, 7
s_add_u32 s6, s6, s7
s_add_u32 s71, s6, 55296
s_mul_i32 s6, s67, 8704
s_add_u32 s6, s6, 110592
v_lshrrev_b32 v12, 5, v1
v_and_b32 v13, 15, v1
v_lshlrev_b32 v14, 4, v12
v_add_u32 v14, v14, v13
v_lshlrev_b32 v14, 4, v14
v_lshlrev_b32 v12, 4, v12
v_add_u32 v12, 512, v12
v_and_b32 v13, 16, v1
v_cmp_eq_u32 vcc, 0, v13
s_nop 1
v_cndmask_b32 v14, v12, v14, vcc
v_add_u32 v8, s6, v14
v_lshrrev_b32 v12, 5, v1
v_lshlrev_b32 v12, 2, v12
v_bfe_u32 v13, v1, 2, 2
v_add_u32 v12, v12, v13
v_lshlrev_b32 v12, 7, v12
v_bfe_u32 v14, v1, 4, 1
v_lshlrev_b32 v14, 1, v14
v_bfe_u32 v15, v1, 1, 1
v_add_u32 v14, v14, v15
v_lshrrev_b32 v15, 1, v13
v_lshlrev_b32 v15, 2, v15
v_xor_b32 v14, v14, v15
v_and_b32 v16, 1, v1
v_lshlrev_b32 v16, 3, v16
v_lshlrev_b32 v17, 4, v14
v_add_u32 v17, v17, v16
v_add_u32 v17, v17, v12
s_lshl_b32 s6, s67, 15
v_add_u32 v10, s6, v17
v_xor_b32 v14, 4, v14
v_lshlrev_b32 v18, 4, v14
v_add_u32 v18, v18, v16
v_add_u32 v18, v18, v12
v_add_u32 v19, s6, v18
v_bfe_u32 v14, v1, 4, 1
v_lshlrev_b32 v14, 1, v14
v_bfe_u32 v17, v1, 1, 1
v_add_u32 v14, v14, v17
s_lshl_b32 s6, s66, 2
v_add_u32 v14, s6, v14
v_xor_b32 v14, v14, v15
v_lshlrev_b32 v14, 4, v14
v_add_u32 v14, v14, v16
v_add_u32 v14, v14, v12
s_lshl_b32 s6, s67, 12
s_add_u32 s6, s6, 102400
v_add_u32 v11, s6, v14
s_mov_b32 s69, 897988541
s_lshl_b32 s6, s64, 16
s_lshl_b32 s7, s66, 15
s_add_u32 s6, s6, s7
s_lshl_b32 s7, s65, 7
s_add_u32 s6, s6, s7
s_lshl_b32 s7, s67, 6
s_add_u32 s70, s6, s7
ds_read_b64_tr_b16 v[216:217], v10 offset:0
ds_read_b64_tr_b16 v[218:219], v10 offset:1024
ds_read_b64_tr_b16 v[220:221], v19 offset:0
ds_read_b64_tr_b16 v[222:223], v19 offset:1024
ds_read_b64_tr_b16 v[224:225], v10 offset:2048
ds_read_b64_tr_b16 v[226:227], v10 offset:3072
ds_read_b64_tr_b16 v[228:229], v19 offset:2048
ds_read_b64_tr_b16 v[230:231], v19 offset:3072
ds_read_b64_tr_b16 v[232:233], v10 offset:4096
ds_read_b64_tr_b16 v[234:235], v10 offset:5120
ds_read_b64_tr_b16 v[236:237], v19 offset:4096
ds_read_b64_tr_b16 v[238:239], v19 offset:5120
ds_read_b64_tr_b16 v[240:241], v10 offset:6144
ds_read_b64_tr_b16 v[242:243], v10 offset:7168
ds_read_b64_tr_b16 v[244:245], v19 offset:6144
ds_read_b64_tr_b16 v[246:247], v19 offset:7168
s_lshl_b32 s6, s5, 12
s_add_u32 s6, s6, 65536
v_add_u32 v23, s6, v20
s_xor_b32 s7, s5, 2
s_lshl_b32 s7, s7, 12
s_add_u32 s7, s7, 65536
v_add_u32 v24, s7, v20
v_and_b32 v25, 31, v1
v_lshlrev_b32 v25, 10, v25
v_lshrrev_b32 v15, 5, v1
v_lshlrev_b32 v15, 4, v15
v_add_u32 v25, v25, v15
s_waitcnt lgkmcnt(0)
s_cmp_lg_u32 s5, 0
s_cbranch_scc1 LF_sp
s_lshl_b32 s6, s64, 7
s_add_u32 s6, s6, 4259840
v_mov_b32 v2, 0
s_mov_b64 exec, 1
LK_poll:
buffer_load_dword v4, v2, s[16:19], s6 offen sc1
s_waitcnt vmcnt(0)
v_readfirstlane_b32 s7, v4
s_nop 1
s_cmp_ge_u32 s7, 8
s_cbranch_scc1 LK_poll_d
s_sleep 4
s_branch LK_poll
LK_poll_d:
s_mov_b64 exec, -1
v_mov_b32 v3, 162816
v_mov_b32 v4, 1
ds_write_b32 v3, v4
s_branch LF_go
LF_sp:
v_mov_b32 v3, 162816
LF_spin:
ds_read_b32 v4, v3
s_waitcnt lgkmcnt(0)
v_readfirstlane_b32 s6, v4
s_nop 1
s_cmp_eq_u32 s6, 0
s_cbranch_scc0 LF_spin_d
s_sleep 1
s_branch LF_spin
LF_spin_d:
LF_go:
s_add_u32 s6, s68, 0
buffer_load_dwordx4 v[64:67], v20, s[16:19], s6 offen offset:0 sc1
buffer_load_dwordx4 v[68:71], v20, s[16:19], s6 offen offset:1024 sc1
buffer_load_dwordx4 v[72:75], v20, s[16:19], s6 offen offset:2048 sc1
buffer_load_dwordx4 v[76:79], v20, s[16:19], s6 offen offset:3072 sc1
s_add_u32 s6, s68, 8192
buffer_load_dwordx4 v[96:99], v20, s[16:19], s6 offen offset:0 sc1
buffer_load_dwordx4 v[100:103], v20, s[16:19], s6 offen offset:1024 sc1
buffer_load_dwordx4 v[104:107], v20, s[16:19], s6 offen offset:2048 sc1
buffer_load_dwordx4 v[108:111], v20, s[16:19], s6 offen offset:3072 sc1
s_add_u32 s6, s68, 4096
buffer_load_dwordx4 v[80:83], v20, s[16:19], s6 offen offset:0 sc1
buffer_load_dwordx4 v[84:87], v20, s[16:19], s6 offen offset:1024 sc1
buffer_load_dwordx4 v[88:91], v20, s[16:19], s6 offen offset:2048 sc1
buffer_load_dwordx4 v[92:95], v20, s[16:19], s6 offen offset:3072 sc1
s_add_u32 s6, s68, 12288
buffer_load_dwordx4 v[112:115], v20, s[16:19], s6 offen offset:0 sc1
buffer_load_dwordx4 v[116:119], v20, s[16:19], s6 offen offset:1024 sc1
buffer_load_dwordx4 v[120:123], v20, s[16:19], s6 offen offset:2048 sc1
buffer_load_dwordx4 v[124:127], v20, s[16:19], s6 offen offset:3072 sc1
buffer_load_dword v6, v22, s[16:19], s71 offen sc1
s_barrier
ds_read_b128 v[128:131], v8 offset:0
ds_read_b128 v[132:135], v8 offset:544
ds_read_b128 v[136:139], v8 offset:1088
ds_read_b128 v[140:143], v8 offset:1632
s_waitcnt lgkmcnt(3) vmcnt(16)
v_mfma_f32_32x32x16_bf16 v[144:159], v[128:131], v[64:67], 0
ds_read_b128 v[128:131], v8 offset:4352
s_waitcnt lgkmcnt(3) vmcnt(15)
v_mfma_f32_32x32x16_bf16 v[160:175], v[132:135], v[68:71], 0
ds_read_b128 v[132:135], v8 offset:4896
s_waitcnt lgkmcnt(3) vmcnt(14)
v_mfma_f32_32x32x16_bf16 v[176:191], v[136:139], v[72:75], 0
ds_read_b128 v[136:139], v8 offset:5440
s_waitcnt lgkmcnt(3) vmcnt(13)
v_mfma_f32_32x32x16_bf16 v[192:207], v[140:143], v[76:79], 0
ds_read_b128 v[140:143], v8 offset:5984
s_nop 1
v_add_f32 v152, s69, v152
v_rcp_f32 v152, v152
s_nop 0
v_mul_f32 v144, v144, v152
v_add_f32 v168, s69, v168
v_rcp_f32 v168, v168
v_mul_f32 v145, v145, v152
v_mul_f32 v146, v146, v152
v_mul_f32 v147, v147, v152
v_mul_f32 v148, v148, v152
v_mul_f32 v149, v149, v152
v_add_f32 v184, s69, v184
v_rcp_f32 v184, v184
v_mul_f32 v150, v150, v152
v_mul_f32 v151, v151, v152
v_cvt_pk_bf16_f32 v208, v144, v145
v_cvt_pk_bf16_f32 v209, v146, v147
v_cvt_pk_bf16_f32 v210, v148, v149
v_add_f32 v200, s69, v200
v_rcp_f32 v200, v200
v_cvt_pk_bf16_f32 v211, v150, v151
s_waitcnt lgkmcnt(3) vmcnt(12)
v_mfma_f32_32x32x16_bf16 v[144:159], v[128:131], v[96:99], 0
v_mul_f32 v160, v160, v168
v_mul_f32 v161, v161, v168
v_mul_f32 v162, v162, v168
v_mul_f32 v163, v163, v168
v_mul_f32 v164, v164, v168
v_mul_f32 v165, v165, v168
v_mul_f32 v166, v166, v168
v_mfma_f32_32x32x16_bf16 v[32:47], v[216:219], v[208:211], 0
v_mul_f32 v167, v167, v168
v_cvt_pk_bf16_f32 v212, v160, v161
v_cvt_pk_bf16_f32 v213, v162, v163
v_cvt_pk_bf16_f32 v214, v164, v165
v_cvt_pk_bf16_f32 v215, v166, v167
v_mul_f32 v176, v176, v184
v_mul_f32 v177, v177, v184
v_mfma_f32_32x32x16_bf16 v[48:63], v[220:223], v[208:211], 0
v_mul_f32 v178, v178, v184
v_mul_f32 v179, v179, v184
v_mul_f32 v180, v180, v184
v_mul_f32 v181, v181, v184
v_mul_f32 v182, v182, v184
v_mul_f32 v183, v183, v184
v_cvt_pk_bf16_f32 v208, v176, v177
s_waitcnt lgkmcnt(2) vmcnt(11)
v_mfma_f32_32x32x16_bf16 v[160:175], v[132:135], v[100:103], 0
v_cvt_pk_bf16_f32 v209, v178, v179
v_cvt_pk_bf16_f32 v210, v180, v181
v_cvt_pk_bf16_f32 v211, v182, v183
v_mul_f32 v192, v192, v200
v_mul_f32 v193, v193, v200
v_mul_f32 v194, v194, v200
v_mul_f32 v195, v195, v200
v_mfma_f32_32x32x16_bf16 v[32:47], v[224:227], v[212:215], v[32:47]
v_mul_f32 v196, v196, v200
v_mul_f32 v197, v197, v200
v_mul_f32 v198, v198, v200
v_mul_f32 v199, v199, v200
ds_read_b64_tr_b16 v[216:217], v10 offset:16384
ds_read_b64_tr_b16 v[218:219], v10 offset:17408
ds_read_b64_tr_b16 v[220:221], v19 offset:16384
v_mfma_f32_32x32x16_bf16 v[48:63], v[228:231], v[212:215], v[48:63]
v_cvt_pk_bf16_f32 v212, v192, v193
v_cvt_pk_bf16_f32 v213, v194, v195
v_cvt_pk_bf16_f32 v214, v196, v197
v_cvt_pk_bf16_f32 v215, v198, v199
ds_read_b64_tr_b16 v[222:223], v19 offset:17408
ds_read_b64_tr_b16 v[224:225], v10 offset:18432
ds_read_b64_tr_b16 v[226:227], v10 offset:19456
s_waitcnt lgkmcnt(7) vmcnt(10)
v_mfma_f32_32x32x16_bf16 v[176:191], v[136:139], v[104:107], 0
ds_read_b64_tr_b16 v[228:229], v19 offset:18432
ds_read_b64_tr_b16 v[230:231], v19 offset:19456
v_add_f32 v152, s69, v152
v_rcp_f32 v152, v152
v_add_f32 v168, s69, v168
v_rcp_f32 v168, v168
s_waitcnt lgkmcnt(8) vmcnt(9)
v_mfma_f32_32x32x16_bf16 v[192:207], v[140:143], v[108:111], 0
v_mul_f32 v144, v144, v152
v_mul_f32 v145, v145, v152
v_mul_f32 v146, v146, v152
v_mul_f32 v147, v147, v152
v_mul_f32 v148, v148, v152
v_mul_f32 v149, v149, v152
v_mul_f32 v150, v150, v152
v_mfma_f32_32x32x16_bf16 v[32:47], v[232:235], v[208:211], v[32:47]
ds_read_b64_tr_b16 v[232:233], v10 offset:20480
ds_read_b64_tr_b16 v[234:235], v10 offset:21504
v_mul_f32 v151, v151, v152
v_mul_f32 v160, v160, v168
v_mul_f32 v161, v161, v168
v_mul_f32 v162, v162, v168
v_mul_f32 v163, v163, v168
v_mfma_f32_32x32x16_bf16 v[48:63], v[236:239], v[208:211], v[48:63]
ds_read_b64_tr_b16 v[236:237], v19 offset:20480
ds_read_b64_tr_b16 v[238:239], v19 offset:21504
v_add_f32 v184, s69, v184
v_rcp_f32 v184, v184
v_cvt_pk_bf16_f32 v208, v144, v145
v_cvt_pk_bf16_f32 v209, v146, v147
v_mfma_f32_32x32x16_bf16 v[32:47], v[240:243], v[212:215], v[32:47]
ds_read_b64_tr_b16 v[240:241], v10 offset:22528
ds_read_b64_tr_b16 v[242:243], v10 offset:23552
v_add_f32 v200, s69, v200
v_rcp_f32 v200, v200
v_cvt_pk_bf16_f32 v210, v148, v149
v_cvt_pk_bf16_f32 v211, v150, v151
v_mfma_f32_32x32x16_bf16 v[48:63], v[244:247], v[212:215], v[48:63]
ds_read_b64_tr_b16 v[244:245], v19 offset:22528
ds_read_b64_tr_b16 v[246:247], v19 offset:23552
v_mul_f32 v164, v164, v168
v_mul_f32 v165, v165, v168
v_mul_f32 v166, v166, v168
v_mul_f32 v167, v167, v168
v_cvt_pk_bf16_f32 v212, v160, v161
s_waitcnt lgkmcnt(14)
v_mfma_f32_32x32x16_bf16 v[32:47], v[216:219], v[208:211], v[32:47]
v_cvt_pk_bf16_f32 v213, v162, v163
v_cvt_pk_bf16_f32 v214, v164, v165
v_cvt_pk_bf16_f32 v215, v166, v167
v_mul_f32 v176, v176, v184
v_mul_f32 v177, v177, v184
v_mul_f32 v178, v178, v184
v_mul_f32 v179, v179, v184
s_waitcnt lgkmcnt(12)
v_mfma_f32_32x32x16_bf16 v[48:63], v[220:223], v[208:211], v[48:63]
v_mul_f32 v180, v180, v184
v_mul_f32 v181, v181, v184
v_mul_f32 v182, v182, v184
v_mul_f32 v183, v183, v184
v_cvt_pk_bf16_f32 v208, v176, v177
v_cvt_pk_bf16_f32 v209, v178, v179
v_cvt_pk_bf16_f32 v210, v180, v181
s_waitcnt lgkmcnt(10)
v_mfma_f32_32x32x16_bf16 v[32:47], v[224:227], v[212:215], v[32:47]
v_cvt_pk_bf16_f32 v211, v182, v183
v_mul_f32 v192, v192, v200
v_mul_f32 v193, v193, v200
v_mul_f32 v194, v194, v200
v_mul_f32 v195, v195, v200
v_mul_f32 v196, v196, v200
v_mul_f32 v197, v197, v200
s_waitcnt lgkmcnt(8)
v_mfma_f32_32x32x16_bf16 v[48:63], v[228:231], v[212:215], v[48:63]
v_mul_f32 v198, v198, v200
v_mul_f32 v199, v199, v200
v_cvt_pk_bf16_f32 v212, v192, v193
v_cvt_pk_bf16_f32 v213, v194, v195
v_cvt_pk_bf16_f32 v214, v196, v197
v_cvt_pk_bf16_f32 v215, v198, v199
s_waitcnt lgkmcnt(6)
v_mfma_f32_32x32x16_bf16 v[32:47], v[232:235], v[208:211], v[32:47]
s_waitcnt lgkmcnt(4)
v_mfma_f32_32x32x16_bf16 v[48:63], v[236:239], v[208:211], v[48:63]
s_waitcnt lgkmcnt(2)
v_mfma_f32_32x32x16_bf16 v[32:47], v[240:243], v[212:215], v[32:47]
s_waitcnt lgkmcnt(0)
v_mfma_f32_32x32x16_bf16 v[48:63], v[244:247], v[212:215], v[48:63]
s_barrier
ds_read_b128 v[128:131], v8 offset:2176
ds_read_b128 v[132:135], v8 offset:2720
ds_read_b128 v[136:139], v8 offset:3264
ds_read_b128 v[140:143], v8 offset:3808
ds_read_b64_tr_b16 v[216:217], v10 offset:8192
ds_read_b64_tr_b16 v[218:219], v10 offset:9216
ds_read_b64_tr_b16 v[220:221], v19 offset:8192
ds_read_b64_tr_b16 v[222:223], v19 offset:9216
ds_read_b64_tr_b16 v[224:225], v10 offset:10240
ds_read_b64_tr_b16 v[226:227], v10 offset:11264
ds_read_b64_tr_b16 v[228:229], v19 offset:10240
ds_read_b64_tr_b16 v[230:231], v19 offset:11264
ds_read_b64_tr_b16 v[232:233], v10 offset:12288
ds_read_b64_tr_b16 v[234:235], v10 offset:13312
ds_read_b64_tr_b16 v[236:237], v19 offset:12288
ds_read_b64_tr_b16 v[238:239], v19 offset:13312
ds_read_b64_tr_b16 v[240:241], v10 offset:14336
ds_read_b64_tr_b16 v[242:243], v10 offset:15360
ds_read_b64_tr_b16 v[244:245], v19 offset:14336
ds_read_b64_tr_b16 v[246:247], v19 offset:15360
s_waitcnt lgkmcnt(15) vmcnt(8)
v_mfma_f32_32x32x16_bf16 v[144:159], v[128:131], v[80:83], 0
ds_read_b128 v[128:131], v8 offset:6528
s_waitcnt vmcnt(7)
v_mfma_f32_32x32x16_bf16 v[160:175], v[132:135], v[84:87], 0
ds_read_b128 v[132:135], v8 offset:7072
s_waitcnt vmcnt(6)
v_mfma_f32_32x32x16_bf16 v[176:191], v[136:139], v[88:91], 0
ds_read_b128 v[136:139], v8 offset:7616
s_waitcnt vmcnt(5)
v_mfma_f32_32x32x16_bf16 v[192:207], v[140:143], v[92:95], 0
ds_read_b128 v[140:143], v8 offset:8160
s_nop 1
v_add_f32 v152, s69, v152
v_rcp_f32 v152, v152
s_nop 0
v_mul_f32 v144, v144, v152
v_add_f32 v168, s69, v168
v_rcp_f32 v168, v168
v_mul_f32 v145, v145, v152
v_mul_f32 v146, v146, v152
v_mul_f32 v147, v147, v152
v_mul_f32 v148, v148, v152
v_mul_f32 v149, v149, v152
v_add_f32 v184, s69, v184
v_rcp_f32 v184, v184
v_mul_f32 v150, v150, v152
v_mul_f32 v151, v151, v152
v_cvt_pk_bf16_f32 v208, v144, v145
v_cvt_pk_bf16_f32 v209, v146, v147
v_cvt_pk_bf16_f32 v210, v148, v149
v_add_f32 v200, s69, v200
v_rcp_f32 v200, v200
v_cvt_pk_bf16_f32 v211, v150, v151
s_waitcnt lgkmcnt(3) vmcnt(4)
v_mfma_f32_32x32x16_bf16 v[144:159], v[128:131], v[112:115], 0
v_mul_f32 v160, v160, v168
v_mul_f32 v161, v161, v168
v_mul_f32 v162, v162, v168
v_mul_f32 v163, v163, v168
v_mul_f32 v164, v164, v168
v_mul_f32 v165, v165, v168
v_mul_f32 v166, v166, v168
v_mfma_f32_32x32x16_bf16 v[32:47], v[216:219], v[208:211], v[32:47]
v_mul_f32 v167, v167, v168
v_cvt_pk_bf16_f32 v212, v160, v161
v_cvt_pk_bf16_f32 v213, v162, v163
v_cvt_pk_bf16_f32 v214, v164, v165
v_cvt_pk_bf16_f32 v215, v166, v167
v_mul_f32 v176, v176, v184
v_mul_f32 v177, v177, v184
v_mfma_f32_32x32x16_bf16 v[48:63], v[220:223], v[208:211], v[48:63]
v_mul_f32 v178, v178, v184
v_mul_f32 v179, v179, v184
v_mul_f32 v180, v180, v184
v_mul_f32 v181, v181, v184
v_mul_f32 v182, v182, v184
v_mul_f32 v183, v183, v184
v_cvt_pk_bf16_f32 v208, v176, v177
s_waitcnt lgkmcnt(2) vmcnt(3)
v_mfma_f32_32x32x16_bf16 v[160:175], v[132:135], v[116:119], 0
v_cvt_pk_bf16_f32 v209, v178, v179
v_cvt_pk_bf16_f32 v210, v180, v181
v_cvt_pk_bf16_f32 v211, v182, v183
v_mul_f32 v192, v192, v200
v_mul_f32 v193, v193, v200
v_mul_f32 v194, v194, v200
v_mul_f32 v195, v195, v200
v_mfma_f32_32x32x16_bf16 v[32:47], v[224:227], v[212:215], v[32:47]
v_mul_f32 v196, v196, v200
v_mul_f32 v197, v197, v200
v_mul_f32 v198, v198, v200
v_mul_f32 v199, v199, v200
ds_read_b64_tr_b16 v[216:217], v10 offset:24576
ds_read_b64_tr_b16 v[218:219], v10 offset:25600
ds_read_b64_tr_b16 v[220:221], v19 offset:24576
v_mfma_f32_32x32x16_bf16 v[48:63], v[228:231], v[212:215], v[48:63]
v_cvt_pk_bf16_f32 v212, v192, v193
v_cvt_pk_bf16_f32 v213, v194, v195
v_cvt_pk_bf16_f32 v214, v196, v197
v_cvt_pk_bf16_f32 v215, v198, v199
ds_read_b64_tr_b16 v[222:223], v19 offset:25600
ds_read_b64_tr_b16 v[224:225], v10 offset:26624
ds_read_b64_tr_b16 v[226:227], v10 offset:27648
s_waitcnt lgkmcnt(7) vmcnt(2)
v_mfma_f32_32x32x16_bf16 v[176:191], v[136:139], v[120:123], 0
ds_read_b64_tr_b16 v[228:229], v19 offset:26624
ds_read_b64_tr_b16 v[230:231], v19 offset:27648
v_add_f32 v152, s69, v152
v_rcp_f32 v152, v152
v_add_f32 v168, s69, v168
v_rcp_f32 v168, v168
s_waitcnt lgkmcnt(8) vmcnt(1)
v_mfma_f32_32x32x16_bf16 v[192:207], v[140:143], v[124:127], 0
v_mul_f32 v144, v144, v152
v_mul_f32 v145, v145, v152
v_mul_f32 v146, v146, v152
v_mul_f32 v147, v147, v152
v_mul_f32 v148, v148, v152
v_mul_f32 v149, v149, v152
v_mul_f32 v150, v150, v152
v_mfma_f32_32x32x16_bf16 v[32:47], v[232:235], v[208:211], v[32:47]
ds_read_b64_tr_b16 v[232:233], v10 offset:28672
ds_read_b64_tr_b16 v[234:235], v10 offset:29696
v_mul_f32 v151, v151, v152
v_mul_f32 v160, v160, v168
v_mul_f32 v161, v161, v168
v_mul_f32 v162, v162, v168
v_mul_f32 v163, v163, v168
v_mfma_f32_32x32x16_bf16 v[48:63], v[236:239], v[208:211], v[48:63]
ds_read_b64_tr_b16 v[236:237], v19 offset:28672
ds_read_b64_tr_b16 v[238:239], v19 offset:29696
v_add_f32 v184, s69, v184
v_rcp_f32 v184, v184
v_cvt_pk_bf16_f32 v208, v144, v145
v_cvt_pk_bf16_f32 v209, v146, v147
v_mfma_f32_32x32x16_bf16 v[32:47], v[240:243], v[212:215], v[32:47]
ds_read_b64_tr_b16 v[240:241], v10 offset:30720
ds_read_b64_tr_b16 v[242:243], v10 offset:31744
v_add_f32 v200, s69, v200
v_rcp_f32 v200, v200
v_cvt_pk_bf16_f32 v210, v148, v149
v_cvt_pk_bf16_f32 v211, v150, v151
v_mfma_f32_32x32x16_bf16 v[48:63], v[244:247], v[212:215], v[48:63]
ds_read_b64_tr_b16 v[244:245], v19 offset:30720
ds_read_b64_tr_b16 v[246:247], v19 offset:31744
v_mul_f32 v164, v164, v168
v_mul_f32 v165, v165, v168
v_mul_f32 v166, v166, v168
v_mul_f32 v167, v167, v168
v_cvt_pk_bf16_f32 v212, v160, v161
s_waitcnt lgkmcnt(14)
v_mfma_f32_32x32x16_bf16 v[32:47], v[216:219], v[208:211], v[32:47]
v_cvt_pk_bf16_f32 v213, v162, v163
v_cvt_pk_bf16_f32 v214, v164, v165
v_cvt_pk_bf16_f32 v215, v166, v167
v_mul_f32 v176, v176, v184
v_mul_f32 v177, v177, v184
v_mul_f32 v178, v178, v184
v_mul_f32 v179, v179, v184
s_waitcnt lgkmcnt(12)
v_mfma_f32_32x32x16_bf16 v[48:63], v[220:223], v[208:211], v[48:63]
v_mul_f32 v180, v180, v184
v_mul_f32 v181, v181, v184
v_mul_f32 v182, v182, v184
v_mul_f32 v183, v183, v184
v_cvt_pk_bf16_f32 v208, v176, v177
v_cvt_pk_bf16_f32 v209, v178, v179
v_cvt_pk_bf16_f32 v210, v180, v181
s_waitcnt lgkmcnt(10)
v_mfma_f32_32x32x16_bf16 v[32:47], v[224:227], v[212:215], v[32:47]
v_cvt_pk_bf16_f32 v211, v182, v183
v_mul_f32 v192, v192, v200
v_mul_f32 v193, v193, v200
v_mul_f32 v194, v194, v200
v_mul_f32 v195, v195, v200
v_mul_f32 v196, v196, v200
v_mul_f32 v197, v197, v200
s_waitcnt lgkmcnt(8)
v_mfma_f32_32x32x16_bf16 v[48:63], v[228:231], v[212:215], v[48:63]
v_mul_f32 v198, v198, v200
v_mul_f32 v199, v199, v200
v_cvt_pk_bf16_f32 v212, v192, v193
v_cvt_pk_bf16_f32 v213, v194, v195
v_cvt_pk_bf16_f32 v214, v196, v197
v_cvt_pk_bf16_f32 v215, v198, v199
s_waitcnt lgkmcnt(6)
v_mfma_f32_32x32x16_bf16 v[32:47], v[232:235], v[208:211], v[32:47]
s_waitcnt lgkmcnt(4)
v_mfma_f32_32x32x16_bf16 v[48:63], v[236:239], v[208:211], v[48:63]
s_waitcnt lgkmcnt(2)
v_mfma_f32_32x32x16_bf16 v[32:47], v[240:243], v[212:215], v[32:47]
s_waitcnt lgkmcnt(0)
v_mfma_f32_32x32x16_bf16 v[48:63], v[244:247], v[212:215], v[48:63]
s_waitcnt vmcnt(0)
v_sub_f32 v7, 1.0, v6
s_cmp_eq_u32 s67, 0
s_cbranch_scc1 LF_hh0
s_nop 5
ds_write_b128 v23, v[32:35] offset:0
ds_write_b128 v23, v[36:39] offset:1024
ds_write_b128 v23, v[40:43] offset:2048
ds_write_b128 v23, v[44:47] offset:3072
v_pk_mul_f32 v[64:65], v[48:49], v[6:7] op_sel:[0,1] op_sel_hi:[1,1]
v_pk_mul_f32 v[66:67], v[50:51], v[6:7] op_sel:[0,1] op_sel_hi:[1,1]
v_pk_mul_f32 v[68:69], v[52:53], v[6:7] op_sel:[0,1] op_sel_hi:[1,1]
v_pk_mul_f32 v[70:71], v[54:55], v[6:7] op_sel:[0,1] op_sel_hi:[1,1]
v_pk_mul_f32 v[72:73], v[56:57], v[6:7] op_sel:[0,1] op_sel_hi:[1,1]
v_pk_mul_f32 v[74:75], v[58:59], v[6:7] op_sel:[0,1] op_sel_hi:[1,1]
v_pk_mul_f32 v[76:77], v[60:61], v[6:7] op_sel:[0,1] op_sel_hi:[1,1]
v_pk_mul_f32 v[78:79], v[62:63], v[6:7] op_sel:[0,1] op_sel_hi:[1,1]
s_branch LF_hhj
LF_hh0:
s_nop 7
ds_write_b128 v23, v[48:51] offset:0
ds_write_b128 v23, v[52:55] offset:1024
ds_write_b128 v23, v[56:59] offset:2048
ds_write_b128 v23, v[60:63] offset:3072
v_pk_mul_f32 v[64:65], v[32:33], v[6:7] op_sel:[0,1] op_sel_hi:[1,1]
v_pk_mul_f32 v[66:67], v[34:35], v[6:7] op_sel:[0,1] op_sel_hi:[1,1]
v_pk_mul_f32 v[68:69], v[36:37], v[6:7] op_sel:[0,1] op_sel_hi:[1,1]
v_pk_mul_f32 v[70:71], v[38:39], v[6:7] op_sel:[0,1] op_sel_hi:[1,1]
v_pk_mul_f32 v[72:73], v[40:41], v[6:7] op_sel:[0,1] op_sel_hi:[1,1]
v_pk_mul_f32 v[74:75], v[42:43], v[6:7] op_sel:[0,1] op_sel_hi:[1,1]
v_pk_mul_f32 v[76:77], v[44:45], v[6:7] op_sel:[0,1] op_sel_hi:[1,1]
v_pk_mul_f32 v[78:79], v[46:47], v[6:7] op_sel:[0,1] op_sel_hi:[1,1]
LF_hhj:
s_waitcnt lgkmcnt(0)
s_barrier
ds_read_b64_tr_b16 v[96:97], v11 offset:0
ds_read_b64_tr_b16 v[98:99], v11 offset:1024
ds_read_b64_tr_b16 v[100:101], v11 offset:2048
ds_read_b64_tr_b16 v[102:103], v11 offset:3072
ds_read_b128 v[112:115], v24 offset:0
ds_read_b128 v[116:119], v24 offset:1024
ds_read_b128 v[120:123], v24 offset:2048
ds_read_b128 v[124:127], v24 offset:3072
s_waitcnt lgkmcnt(7)
v_lshlrev_b32 v136, 16, v96
v_and_b32 v137, 0xffff0000, v96
v_lshlrev_b32 v138, 16, v97
v_and_b32 v139, 0xffff0000, v97
s_waitcnt lgkmcnt(6)
v_lshlrev_b32 v140, 16, v98
v_and_b32 v141, 0xffff0000, v98
v_lshlrev_b32 v142, 16, v99
v_and_b32 v143, 0xffff0000, v99
v_pk_fma_f32 v[64:65], v[136:137], v[6:7], v[64:65] op_sel_hi:[1,0,1]
v_pk_fma_f32 v[66:67], v[138:139], v[6:7], v[66:67] op_sel_hi:[1,0,1]
v_pk_fma_f32 v[68:69], v[140:141], v[6:7], v[68:69] op_sel_hi:[1,0,1]
v_pk_fma_f32 v[70:71], v[142:143], v[6:7], v[70:71] op_sel_hi:[1,0,1]
s_waitcnt lgkmcnt(5)
v_lshlrev_b32 v144, 16, v100
v_and_b32 v145, 0xffff0000, v100
v_lshlrev_b32 v146, 16, v101
v_and_b32 v147, 0xffff0000, v101
s_waitcnt lgkmcnt(4)
v_lshlrev_b32 v148, 16, v102
v_and_b32 v149, 0xffff0000, v102
v_lshlrev_b32 v150, 16, v103
v_and_b32 v151, 0xffff0000, v103
s_waitcnt lgkmcnt(3)
v_pk_fma_f32 v[64:65], v[112:113], v[6:7], v[64:65] op_sel:[0,1,0] op_sel_hi:[1,1,1]
v_pk_fma_f32 v[66:67], v[114:115], v[6:7], v[66:67] op_sel:[0,1,0] op_sel_hi:[1,1,1]
s_waitcnt lgkmcnt(2)
v_pk_fma_f32 v[68:69], v[116:117], v[6:7], v[68:69] op_sel:[0,1,0] op_sel_hi:[1,1,1]
v_pk_fma_f32 v[70:71], v[118:119], v[6:7], v[70:71] op_sel:[0,1,0] op_sel_hi:[1,1,1]
v_pk_fma_f32 v[72:73], v[144:145], v[6:7], v[72:73] op_sel_hi:[1,0,1]
v_pk_fma_f32 v[74:75], v[146:147], v[6:7], v[74:75] op_sel_hi:[1,0,1]
v_pk_fma_f32 v[76:77], v[148:149], v[6:7], v[76:77] op_sel_hi:[1,0,1]
v_pk_fma_f32 v[78:79], v[150:151], v[6:7], v[78:79] op_sel_hi:[1,0,1]
v_cvt_pk_bf16_f32 v128, v64, v65
v_cvt_pk_bf16_f32 v129, v66, v67
v_cvt_pk_bf16_f32 v130, v68, v69
v_cvt_pk_bf16_f32 v131, v70, v71
s_waitcnt lgkmcnt(1)
v_pk_fma_f32 v[72:73], v[120:121], v[6:7], v[72:73] op_sel:[0,1,0] op_sel_hi:[1,1,1]
v_pk_fma_f32 v[74:75], v[122:123], v[6:7], v[74:75] op_sel:[0,1,0] op_sel_hi:[1,1,1]
s_waitcnt lgkmcnt(0)
v_pk_fma_f32 v[76:77], v[124:125], v[6:7], v[76:77] op_sel:[0,1,0] op_sel_hi:[1,1,1]
v_pk_fma_f32 v[78:79], v[126:127], v[6:7], v[78:79] op_sel:[0,1,0] op_sel_hi:[1,1,1]
v_cvt_pk_bf16_f32 v132, v72, v73
v_cvt_pk_bf16_f32 v133, v74, v75
v_cvt_pk_bf16_f32 v134, v76, v77
v_cvt_pk_bf16_f32 v135, v78, v79
v_permlane32_swap_b32 v128, v130
v_permlane32_swap_b32 v129, v131
buffer_store_dwordx4 v[128:131], v25, s[28:31], s70 offen offset:0
v_permlane32_swap_b32 v132, v134
v_permlane32_swap_b32 v133, v135
buffer_store_dwordx4 v[132:135], v25, s[28:31], s70 offen offset:32
s_branch LF_end
LF_aux:
s_sub_u32 s66, s5, 4
v_readfirstlane_b32 s75, v2
v_lshlrev_b32 v20, 4, v1
s_sub_u32 s6, s5, 4
s_lshl_b32 s6, s6, 2
s_lshl_b32 s7, s6, 11
s_add_u32 s7, s7, 65536
v_lshlrev_b32 v8, 2, v1
v_add_u32 v8, s7, v8
v_bfe_u32 v12, v1, 4, 1
v_lshlrev_b32 v12, 6, v12
v_lshrrev_b32 v13, 5, v1
v_lshlrev_b32 v13, 4, v13
v_add_u32 v12, v12, v13
s_lshr_b32 s7, s6, 2
s_lshl_b32 s7, s7, 10
s_and_b32 s74, s6, 3
s_lshl_b32 s74, s74, 7
s_add_u32 s7, s7, s74
s_add_u32 s7, s7, 98304
v_add_u32 v9, s7, v12
s_mul_i32 s7, s6, 1088
s_add_u32 s7, s7, 110592
v_bfe_u32 v12, v1, 4, 1
v_mul_u32_u24 v12, 544, v12
v_lshrrev_b32 v13, 5, v1
v_lshlrev_b32 v14, 8, v13
v_add_u32 v14, v14, v12
v_and_b32 v15, 15, v1
v_lshlrev_b32 v15, 4, v15
v_add_u32 v14, v14, v15
v_add_u32 v10, s7, v14
v_lshlrev_b32 v13, 4, v13
v_add_u32 v13, v13, v12
v_add_u32 v13, 512, v13
v_add_u32 v11, s7, v13
s_cmp_lg_u32 s66, 0
s_cbranch_scc1 LF_asp
LF_azp:
v_mov_b32 v2, 0
global_load_dword v2, v2, s[60:61] sc1
s_waitcnt vmcnt(0)
v_readfirstlane_b32 s6, v2
s_nop 1
s_cmp_ge_u32 s6, 37
s_cbranch_scc0 LF_azp
s_and_b32 s6, s2, 15
s_lshl_b32 s6, s6, 7
s_add_u32 s6, s6, 4268032
v_lshlrev_b32 v2, 11, v1
s_mov_b64 exec, 0xff
LF_apoll:
buffer_load_dword v4, v2, s[16:19], s6 offen sc1
s_waitcnt vmcnt(0)
v_cmp_gt_u32 vcc, 16, v4
s_nop 4
s_cbranch_vccz LF_apoll_d
s_sleep 4
s_branch LF_apoll
LF_apoll_d:
s_mov_b64 exec, -1
v_mov_b32 v3, 162820
v_mov_b32 v4, 1
ds_write_b32 v3, v4
s_branch LF_ago
LF_asp:
v_mov_b32 v3, 162820
LF_aspin:
ds_read_b32 v4, v3
s_waitcnt lgkmcnt(0)
v_readfirstlane_b32 s6, v4
s_nop 1
s_cmp_eq_u32 s6, 0
s_cbranch_scc0 LF_aspin_d
s_sleep 1
s_branch LF_aspin
LF_aspin_d:
LF_ago:
s_setprio 2
s_lshl_b32 s67, s66, 13
s_lshl_b32 s6, s66, 9
s_add_u32 s6, s6, 32768
s_lshl_b32 s7, s66, 10
s_add_u32 m0, s7, 98304
s_mov_b64 exec, 0xffffffff
buffer_load_dwordx4 v20, s[16:19], s6 offen sc1 lds
s_mov_b64 exec, -1
s_add_u32 s6, s67, 0
s_add_u32 m0, s67, 65536
s_nop 0
buffer_load_dwordx4 v20, s[16:19], s6 offen sc1 lds
s_add_u32 s6, s67, 1024
s_add_u32 m0, s67, 66560
s_nop 0
buffer_load_dwordx4 v20, s[16:19], s6 offen sc1 lds
s_add_u32 s6, s67, 2048
s_add_u32 m0, s67, 67584
s_nop 0
buffer_load_dwordx4 v20, s[16:19], s6 offen sc1 lds
s_add_u32 s6, s67, 3072
s_add_u32 m0, s67, 68608
s_nop 0
buffer_load_dwordx4 v20, s[16:19], s6 offen sc1 lds
s_add_u32 s6, s67, 4096
s_add_u32 m0, s67, 69632
s_nop 0
buffer_load_dwordx4 v20, s[16:19], s6 offen sc1 lds
s_add_u32 s6, s67, 5120
s_add_u32 m0, s67, 70656
s_nop 0
buffer_load_dwordx4 v20, s[16:19], s6 offen sc1 lds
s_add_u32 s6, s67, 6144
s_add_u32 m0, s67, 71680
s_nop 0
buffer_load_dwordx4 v20, s[16:19], s6 offen sc1 lds
s_add_u32 s6, s67, 7168
s_add_u32 m0, s67, 72704
s_nop 0
buffer_load_dwordx4 v20, s[16:19], s6 offen sc1 lds
s_setprio 0
s_waitcnt vmcnt(4)
ds_read2st64_b32 v[32:33], v8 offset0:0 offset1:1
ds_read2st64_b32 v[34:35], v8 offset0:2 offset1:3
ds_read2st64_b32 v[36:37], v8 offset0:4 offset1:5
ds_read2st64_b32 v[38:39], v8 offset0:6 offset1:7
ds_read_b128 v[40:43], v9 offset:0
ds_read_b128 v[44:47], v9 offset:32
ds_read2st64_b32 v[48:49], v8 offset0:8 offset1:9
ds_read2st64_b32 v[50:51], v8 offset0:10 offset1:11
ds_read2st64_b32 v[52:53], v8 offset0:12 offset1:13
ds_read2st64_b32 v[54:55], v8 offset0:14 offset1:15
ds_read_b128 v[56:59], v9 offset:128
ds_read_b128 v[60:63], v9 offset:160
s_waitcnt lgkmcnt(11)
v_cvt_pk_bf16_f32 v96, v32, v33
s_waitcnt lgkmcnt(10)
v_cvt_pk_bf16_f32 v97, v34, v35
s_waitcnt lgkmcnt(9)
v_cvt_pk_bf16_f32 v98, v36, v37
s_waitcnt lgkmcnt(8)
v_cvt_pk_bf16_f32 v99, v38, v39
ds_write_b128 v10, v[96:99] offset:0
s_waitcnt lgkmcnt(6)
v_cvt_pk_bf16_f32 v104, v48, v49
s_waitcnt lgkmcnt(5)
v_cvt_pk_bf16_f32 v105, v50, v51
s_waitcnt lgkmcnt(4)
v_cvt_pk_bf16_f32 v106, v52, v53
s_waitcnt lgkmcnt(3)
v_cvt_pk_bf16_f32 v107, v54, v55
ds_write_b128 v10, v[104:107] offset:1088
v_cvt_pk_bf16_f32 v100, v40, v41
v_cvt_pk_bf16_f32 v101, v42, v43
v_cvt_pk_bf16_f32 v102, v44, v45
v_cvt_pk_bf16_f32 v103, v46, v47
s_waitcnt lgkmcnt(3)
v_cvt_pk_bf16_f32 v108, v56, v57
v_cvt_pk_bf16_f32 v109, v58, v59
s_waitcnt lgkmcnt(2)
v_cvt_pk_bf16_f32 v110, v60, v61
v_cvt_pk_bf16_f32 v111, v62, v63
s_mov_b32 exec_lo, 0x00010001
s_mov_b32 exec_hi, 0x00010001
ds_write_b128 v11, v[100:103] offset:0
ds_write_b128 v11, v[108:111] offset:1088
s_mov_b64 exec, -1
s_waitcnt lgkmcnt(0)
s_barrier
s_waitcnt vmcnt(0)
ds_read2st64_b32 v[64:65], v8 offset0:16 offset1:17
ds_read2st64_b32 v[66:67], v8 offset0:18 offset1:19
ds_read2st64_b32 v[68:69], v8 offset0:20 offset1:21
ds_read2st64_b32 v[70:71], v8 offset0:22 offset1:23
ds_read_b128 v[72:75], v9 offset:256
ds_read_b128 v[76:79], v9 offset:288
ds_read2st64_b32 v[80:81], v8 offset0:24 offset1:25
ds_read2st64_b32 v[82:83], v8 offset0:26 offset1:27
ds_read2st64_b32 v[84:85], v8 offset0:28 offset1:29
ds_read2st64_b32 v[86:87], v8 offset0:30 offset1:31
ds_read_b128 v[88:91], v9 offset:384
ds_read_b128 v[92:95], v9 offset:416
s_waitcnt lgkmcnt(11)
v_cvt_pk_bf16_f32 v112, v64, v65
s_waitcnt lgkmcnt(10)
v_cvt_pk_bf16_f32 v113, v66, v67
s_waitcnt lgkmcnt(9)
v_cvt_pk_bf16_f32 v114, v68, v69
s_waitcnt lgkmcnt(8)
v_cvt_pk_bf16_f32 v115, v70, v71
ds_write_b128 v10, v[112:115] offset:2176
s_waitcnt lgkmcnt(6)
v_cvt_pk_bf16_f32 v120, v80, v81
s_waitcnt lgkmcnt(5)
v_cvt_pk_bf16_f32 v121, v82, v83
s_waitcnt lgkmcnt(4)
v_cvt_pk_bf16_f32 v122, v84, v85
s_waitcnt lgkmcnt(3)
v_cvt_pk_bf16_f32 v123, v86, v87
ds_write_b128 v10, v[120:123] offset:3264
v_cvt_pk_bf16_f32 v116, v72, v73
v_cvt_pk_bf16_f32 v117, v74, v75
v_cvt_pk_bf16_f32 v118, v76, v77
v_cvt_pk_bf16_f32 v119, v78, v79
s_waitcnt lgkmcnt(3)
v_cvt_pk_bf16_f32 v124, v88, v89
v_cvt_pk_bf16_f32 v125, v90, v91
s_waitcnt lgkmcnt(2)
v_cvt_pk_bf16_f32 v126, v92, v93
v_cvt_pk_bf16_f32 v127, v94, v95
s_mov_b32 exec_lo, 0x00010001
s_mov_b32 exec_hi, 0x00010001
ds_write_b128 v11, v[116:119] offset:2176
ds_write_b128 v11, v[124:127] offset:3264
s_mov_b64 exec, -1
s_waitcnt lgkmcnt(0)
s_barrier
s_lshl_b32 s7, s65, 2
s_and_b32 s6, s64, 3
s_add_u32 s7, s7, s6
s_add_u32 s7, s7, 32
s_lshl_b32 s7, s7, 7
s_add_u32 s74, s7, 4259840
v_lshrrev_b32 v21, 3, v1
v_lshlrev_b32 v21, 12, v21
v_and_b32 v14, 7, v1
v_bfe_u32 v15, v1, 4, 1
v_lshlrev_b32 v15, 2, v15
v_xor_b32 v14, v14, v15
v_lshlrev_b32 v14, 4, v14
v_add_u32 v21, v21, v14
s_lshl_b32 s6, s65, 18
s_lshl_b32 s7, s64, 7
s_add_u32 s6, s6, s7
s_lshl_b32 s7, s66, 15
s_add_u32 s6, s6, s7
s_add_u32 s72, s6, 2162688
s_lshl_b32 s73, s66, 10
v_mov_b32 v2, 0
s_mov_b64 exec, 1
LF_cpoll:
buffer_load_dword v4, v2, s[16:19], s74 offen sc1
s_waitcnt vmcnt(0)
v_readfirstlane_b32 s7, v4
s_nop 1
s_cmp_ge_u32 s7, 16
s_cbranch_scc1 LF_cpoll_d
s_sleep 4
s_branch LF_cpoll
LF_cpoll_d:
s_mov_b64 exec, -1
s_add_u32 s6, s72, 0
s_add_u32 m0, s73, 102400
s_nop 0
buffer_load_dwordx4 v21, s[16:19], s6 offen sc1 lds
s_add_u32 s6, s72, 131072
s_add_u32 m0, s73, 106496
s_nop 0
buffer_load_dwordx4 v21, s[16:19], s6 offen sc1 lds
s_waitcnt vmcnt(0)
s_barrier
LF_end:
LK_end:
s_endpgm
KEND_gated_mix__ssm_conv_s4__linear_attn_block__prompt_kernel:
.section .rodata,"a"
.p2align 6
.amdhsa_kernel gated_mix__ssm_conv_s4__linear_attn_block__prompt_kernel
  .amdhsa_next_free_vgpr 256
  .amdhsa_next_free_sgpr 102
  .amdhsa_accum_offset 256
  .amdhsa_group_segment_fixed_size 0
  .amdhsa_kernarg_size 128
  .amdhsa_user_sgpr_count 2
  .amdhsa_user_sgpr_kernarg_segment_ptr 1
  .amdhsa_system_sgpr_workgroup_id_x 1
  .amdhsa_float_denorm_mode_32 3
  .amdhsa_float_denorm_mode_16_64 3
.end_amdhsa_kernel
```
